```python
import torch

def _softmax(x, axis=-1):
    return torch.softmax(x, dim=axis)
def _gelu(x):
    return torch.nn.functional.gelu(x, approximate="tanh")
def _silu(x):
    return torch.nn.functional.silu(x)
def _sigmoid(x):
    return torch.sigmoid(x)
def _layernorm(x, axis=-1, eps=1e-5):
    m = x.mean(dim=axis, keepdim=True)
    v = x.var(dim=axis, keepdim=True, unbiased=False)
    return (x - m) / torch.sqrt(v + eps)
def _scatter_add(tgt, idx, src, axis=0):
    return tgt.clone().index_add_(axis, idx, src)
def _segment_sum(src, seg, n):
    out = torch.zeros((n,) + src.shape[1:], dtype=src.dtype)
    return out.index_add_(0, seg, src)
def _pad(x, pw):
    flat = tuple(v for pair in reversed(pw) for v in pair)
    return torch.nn.functional.pad(x, flat)

kernel_name = 'recurrent_scan__mha_block_cached__glu_gated_geglu__decode'

def setup_inputs():

    _w = (lambda a: (lambda t: t.to(torch.bfloat16) if t.is_floating_point() else t)(torch.as_tensor(a)))
    def _A_setup():
        B, Sq, D = 2, 1, 640
        H, Sk, Dh = 32, 16384, 128
        return {
            "x": _w((lambda *s: torch.randn(*s, dtype=torch.bfloat16) * 0.4)(B, Sq, D)),
            "k_cache": _w((lambda *s: torch.randn(*s, dtype=torch.bfloat16) * 1.6)(B, H, Sk, Dh)),
            "v_cache": _w((lambda *s: torch.randn(*s, dtype=torch.bfloat16) * 1.6)(B, H, Sk, Dh)),
            "wq": _w((lambda *s: torch.randn(*s, dtype=torch.bfloat16) * 1.6)(D, H * Dh) * (D ** -0.5)),
            "wo": _w((lambda *s: torch.randn(*s, dtype=torch.bfloat16) * 1.6)(H * Dh, D) * ((H * Dh) ** -0.5)),
        }
    _A_in = _A_setup()

    def _B_setup():
        B, S, Dm, Df = 2, 1, 640, 1728
        return {
            "x": _w((lambda *s: torch.randn(*s, dtype=torch.bfloat16) * 0.4)(B, S, Dm)),
            "w_gate": _w((lambda *s: torch.randn(*s, dtype=torch.bfloat16) * 1.6)(Dm, Df) * (Dm ** -0.5)),
            "w_up": _w((lambda *s: torch.randn(*s, dtype=torch.bfloat16) * 1.6)(Dm, Df) * (Dm ** -0.5)),
            "w_down": _w((lambda *s: torch.randn(*s, dtype=torch.bfloat16) * 1.6)(Df, Dm) * (Df ** -0.5)),
        }
    _B_in = _B_setup()

    return {
        "A_x": _A_in["x"],
        "A_k_cache": _A_in["k_cache"],
        "A_v_cache": _A_in["v_cache"],
        "A_wq": _A_in["wq"],
        "A_wo": _A_in["wo"],
        "B_x": _B_in["x"],
        "B_w_gate": _B_in["w_gate"],
        "B_w_up": _B_in["w_up"],
        "B_w_down": _B_in["w_down"],
    }

def reference(A_x, A_k_cache, A_v_cache, A_wq, A_wo, B_x, B_w_gate, B_w_up, B_w_down):
    def _A_ref(x, k_cache, v_cache, wq, wo):
        B, Sq, D = x.shape
        H, Dh = 32, 128
        q = (lambda x, *d: x.permute(*d))((x @ wq).reshape(B, Sq, H, Dh), 0, 2, 1, 3)
        scores = torch.einsum("bhqd,bhkd->bhqk", q, k_cache) * (Dh ** -0.5)
        p = _softmax(scores, axis=-1)
        o = torch.einsum("bhqk,bhkd->bhqd", p, v_cache)
        return (lambda x, *d: x.permute(*d))(o, 0, 2, 1, 3).reshape(B, Sq, H * Dh) @ wo

    def _B_ref(x, w_gate, w_up, w_down):
        g = torch.einsum("bsd,df->bsf", x, w_gate)
        u = torch.einsum("bsd,df->bsf", x, w_up)
        h = _gelu(g) * u
        return torch.einsum("bsf,fd->bsd", h, w_down)

    x = A_x
    xn = _layernorm(x, axis=-1)
    s = _A_ref(xn, A_k_cache, A_v_cache, A_wq, A_wo)
    g = _silu(_B_ref(xn, B_w_gate, B_w_up, B_w_down))
    return x + s * g
```

```asm
; @launch grid=(256,1,1) block=(320,1,1) lds=98304
.amdgcn_target "amdgcn-amd-amdhsa--gfx950"
.text
.globl recurrent_scan__mha_block_cached__glu_gated_geglu__decode_kernel
.p2align 8
.type recurrent_scan__mha_block_cached__glu_gated_geglu__decode_kernel,@function
recurrent_scan__mha_block_cached__glu_gated_geglu__decode_kernel:
  s_cmp_ge_u32 s2, 256
  s_cbranch_scc1 L_exit
  s_load_dwordx16 s[36:51], s[0:1], 0
  s_load_dwordx8 s[52:59], s[0:1], 64
  v_lshrrev_b32 v1, 6, v0
  v_and_b32 v0, 63, v0
  v_readfirstlane_b32 s3, v1
  s_lshr_b32 s4, s2, 3
  s_and_b32 s5, s2, 7
  s_sub_u32 s27, s2, 216
  s_mov_b32 s26, 0xffff0000
  s_mov_b32 s72, s3
  s_cmp_lg_u32 s3, 0
  s_cbranch_scc1 L_stream
  v_mov_b32 v59, 0
  ds_write_b32 v59, v59 offset:5632
  ds_write_b32 v59, v59 offset:5636
  v_lshrrev_b32 v14, 5, v0
  v_and_b32 v15, 31, v0
  v_mul_u32_u24 v16, 40, v0
  v_lshrrev_b32 v17, 4, v0
  v_and_b32 v18, 15, v0
  v_lshlrev_b32 v22, 13, v17
  v_lshl_add_u32 v22, v18, 4, v22
  s_mul_i32 s7, s5, 655360
  s_lshl_b32 s24, s4, 8
  s_add_u32 s7, s7, s24
  s_mov_b32 s18, 2560
  s_mov_b32 s19, 0x20000
  s_sub_u32 s10, 0x500000, s7
  s_mov_b32 s11, 0x20000
  s_mov_b32 s24, 0
  s_waitcnt lgkmcnt(0)
  s_mov_b32 s16, s36
  s_mov_b32 s17, s37
  s_add_u32 s8, s42, s7
  s_addc_u32 s9, s43, 0
  buffer_load_dwordx4 v[24:27], v16, s[16:19], 0 offen
  buffer_load_dwordx4 v[28:31], v16, s[16:19], 0 offen offset:16
  buffer_load_dwordx2 v[32:33], v16, s[16:19], 0 offen offset:32
  buffer_load_dwordx4 v[64:67], v22, s[8:11], s24 offen nt
  s_add_u32 s24, s24, 0x8000
  buffer_load_dwordx4 v[68:71], v22, s[8:11], s24 offen nt
  s_add_u32 s24, s24, 0x8000
  buffer_load_dwordx4 v[72:75], v22, s[8:11], s24 offen nt
  s_add_u32 s24, s24, 0x8000
  buffer_load_dwordx4 v[76:79], v22, s[8:11], s24 offen nt
  s_add_u32 s24, s24, 0x8000
  buffer_load_dwordx4 v[80:83], v22, s[8:11], s24 offen nt
  s_add_u32 s24, s24, 0x8000
  buffer_load_dwordx4 v[84:87], v22, s[8:11], s24 offen nt
  s_add_u32 s24, s24, 0x8000
  buffer_load_dwordx4 v[88:91], v22, s[8:11], s24 offen nt
  s_add_u32 s24, s24, 0x8000
  buffer_load_dwordx4 v[92:95], v22, s[8:11], s24 offen nt
  s_add_u32 s24, s24, 0x8000
  buffer_load_dwordx4 v[96:99], v22, s[8:11], s24 offen nt
  s_add_u32 s24, s24, 0x8000
  buffer_load_dwordx4 v[100:103], v22, s[8:11], s24 offen nt
  s_add_u32 s24, s24, 0x8000
  buffer_load_dwordx4 v[104:107], v22, s[8:11], s24 offen nt
  s_add_u32 s24, s24, 0x8000
  buffer_load_dwordx4 v[108:111], v22, s[8:11], s24 offen nt
  s_add_u32 s24, s24, 0x8000
  buffer_load_dwordx4 v[112:115], v22, s[8:11], s24 offen nt
  s_add_u32 s24, s24, 0x8000
  buffer_load_dwordx4 v[116:119], v22, s[8:11], s24 offen nt
  s_add_u32 s24, s24, 0x8000
  buffer_load_dwordx4 v[120:123], v22, s[8:11], s24 offen nt
  s_add_u32 s24, s24, 0x8000
  buffer_load_dwordx4 v[124:127], v22, s[8:11], s24 offen nt
  s_add_u32 s24, s24, 0x8000
  buffer_load_dwordx4 v[128:131], v22, s[8:11], s24 offen nt
  s_add_u32 s24, s24, 0x8000
  buffer_load_dwordx4 v[132:135], v22, s[8:11], s24 offen nt
  s_add_u32 s24, s24, 0x8000
  buffer_load_dwordx4 v[136:139], v22, s[8:11], s24 offen nt
  s_add_u32 s24, s24, 0x8000
  buffer_load_dwordx4 v[140:143], v22, s[8:11], s24 offen nt
  s_load_dword s70, s[58:59], 0
  v_mul_u32_u24 v1, 1280, v17
  v_lshl_add_u32 v1, v18, 4, v1
  s_lshr_b32 s6, s2, 1
  s_lshl_b32 s6, s6, 3
  s_and_b32 s14, s2, 1
  s_add_u32 s6, s6, s14
  s_mul_i32 s6, s6, 5120
  s_mov_b32 s14, 35840
  s_mov_b32 s64, 20480
  s_mov_b32 s65, 30720
  s_add_u32 s12, s44, s6
  s_addc_u32 s13, s45, 0
  s_mov_b32 s15, 0x20000
  s_mov_b32 s60, 5120
  s_mov_b32 s61, 10240
  s_mov_b32 s62, 15360
  s_mov_b32 s74, 0xff00ff00
  s_mov_b32 s75, 0xff00ff00
  s_cmp_ge_u32 s4, 27
  s_cbranch_scc1 L_nogu
  v_mov_b32 v60, s48
  v_mov_b32 v61, s49
  v_mov_b32 v62, s50
  v_mov_b32 v63, s51
  v_cndmask_b32 v60, v60, v62, s[74:75]
  v_cndmask_b32 v61, v61, v63, s[74:75]
  v_and_b32 v19, 7, v0
  v_lshlrev_b32 v62, 4, v19
  v_mul_u32_u24 v63, 3456, v17
  v_add_u32 v62, v62, v63
  s_lshl_b32 s7, s4, 7
  s_mul_i32 s6, s5, 276480
  s_add_u32 s7, s7, s6
  v_add_u32 v62, s7, v62
  v_mov_b32 v63, 0
  v_lshl_add_u64 v[60:61], v[62:63], 0, v[60:61]
  s_mov_b32 s34, 13824
  s_mov_b32 s35, 0
  global_load_dwordx4 v[144:147], v[60:61], off nt
  v_lshl_add_u64 v[60:61], v[60:61], 0, s[34:35]
  global_load_dwordx4 v[148:151], v[60:61], off nt
  v_lshl_add_u64 v[60:61], v[60:61], 0, s[34:35]
  global_load_dwordx4 v[152:155], v[60:61], off nt
  v_lshl_add_u64 v[60:61], v[60:61], 0, s[34:35]
  global_load_dwordx4 v[156:159], v[60:61], off nt
  v_lshl_add_u64 v[60:61], v[60:61], 0, s[34:35]
  global_load_dwordx4 v[160:163], v[60:61], off nt
  v_lshl_add_u64 v[60:61], v[60:61], 0, s[34:35]
  global_load_dwordx4 v[164:167], v[60:61], off nt
  v_lshl_add_u64 v[60:61], v[60:61], 0, s[34:35]
  global_load_dwordx4 v[168:171], v[60:61], off nt
  v_lshl_add_u64 v[60:61], v[60:61], 0, s[34:35]
  global_load_dwordx4 v[172:175], v[60:61], off nt
  v_lshl_add_u64 v[60:61], v[60:61], 0, s[34:35]
  global_load_dwordx4 v[176:179], v[60:61], off nt
  v_lshl_add_u64 v[60:61], v[60:61], 0, s[34:35]
  global_load_dwordx4 v[180:183], v[60:61], off nt
  v_lshl_add_u64 v[60:61], v[60:61], 0, s[34:35]
  global_load_dwordx4 v[184:187], v[60:61], off nt
  v_lshl_add_u64 v[60:61], v[60:61], 0, s[34:35]
  global_load_dwordx4 v[188:191], v[60:61], off nt
  v_lshl_add_u64 v[60:61], v[60:61], 0, s[34:35]
  global_load_dwordx4 v[192:195], v[60:61], off nt
  v_lshl_add_u64 v[60:61], v[60:61], 0, s[34:35]
  global_load_dwordx4 v[196:199], v[60:61], off nt
  v_lshl_add_u64 v[60:61], v[60:61], 0, s[34:35]
  global_load_dwordx4 v[200:203], v[60:61], off nt
  v_lshl_add_u64 v[60:61], v[60:61], 0, s[34:35]
  global_load_dwordx4 v[204:207], v[60:61], off nt
  v_lshl_add_u64 v[60:61], v[60:61], 0, s[34:35]
  global_load_dwordx4 v[208:211], v[60:61], off nt
  v_lshl_add_u64 v[60:61], v[60:61], 0, s[34:35]
  global_load_dwordx4 v[212:215], v[60:61], off nt
  v_lshl_add_u64 v[60:61], v[60:61], 0, s[34:35]
  global_load_dwordx4 v[216:219], v[60:61], off nt
  v_lshl_add_u64 v[60:61], v[60:61], 0, s[34:35]
  global_load_dwordx4 v[220:223], v[60:61], off nt
  s_branch L_gud
L_nogu:
  buffer_load_dwordx4 v[144:147], v1, s[12:15], 0 offen offset:0 nt
  buffer_load_dwordx4 v[148:151], v1, s[12:15], 0 offen offset:256 nt
  buffer_load_dwordx4 v[152:155], v1, s[12:15], 0 offen offset:512 nt
  buffer_load_dwordx4 v[156:159], v1, s[12:15], 0 offen offset:768 nt
  buffer_load_dwordx4 v[160:163], v1, s[12:15], 0 offen offset:1024 nt
  buffer_load_dwordx4 v[164:167], v1, s[12:15], s61 offen offset:0 nt
  buffer_load_dwordx4 v[168:171], v1, s[12:15], s61 offen offset:256 nt
  buffer_load_dwordx4 v[172:175], v1, s[12:15], s61 offen offset:512 nt
  buffer_load_dwordx4 v[176:179], v1, s[12:15], s61 offen offset:768 nt
  buffer_load_dwordx4 v[180:183], v1, s[12:15], s61 offen offset:1024 nt
  buffer_load_dwordx4 v[184:187], v1, s[12:15], s64 offen offset:0 nt
  buffer_load_dwordx4 v[188:191], v1, s[12:15], s64 offen offset:256 nt
  buffer_load_dwordx4 v[192:195], v1, s[12:15], s64 offen offset:512 nt
  buffer_load_dwordx4 v[196:199], v1, s[12:15], s64 offen offset:768 nt
  buffer_load_dwordx4 v[200:203], v1, s[12:15], s64 offen offset:1024 nt
  buffer_load_dwordx4 v[204:207], v1, s[12:15], s65 offen offset:0 nt
  buffer_load_dwordx4 v[208:211], v1, s[12:15], s65 offen offset:256 nt
  buffer_load_dwordx4 v[212:215], v1, s[12:15], s65 offen offset:512 nt
  buffer_load_dwordx4 v[216:219], v1, s[12:15], s65 offen offset:768 nt
  buffer_load_dwordx4 v[220:223], v1, s[12:15], s65 offen offset:1024 nt
L_gud:
  s_mov_b32 s20, s58
  s_mov_b32 s21, s59
  s_mov_b32 s22, 5668864
  s_mov_b32 s23, 0x20000
  v_and_b32 v58, 1, v0
  v_lshlrev_b32 v58, 13, v58
  v_and_b32 v57, 2, v0
  v_lshl_add_u32 v58, v57, 6, v58
  s_lshl_b32 s34, s4, 8
  s_add_u32 s34, s34, 4096
  s_cmp_eq_u32 s5, 0
  s_cselect_b32 exec_lo, 15, 0
  s_mov_b32 exec_hi, 0
  buffer_atomic_swap v59, v58, s[20:23], s34 offen sc1
  s_mov_b64 exec, -1
  s_barrier
  v_and_b32 v19, 1, v0
  v_cmp_eq_u32 vcc, 1, v19
  v_mov_b32 v20, 0xffff
  v_mov_b32 v21, s26
  v_cndmask_b32 v20, v20, v21, vcc
  v_bfe_u32 v19, v0, 1, 2
  v_cmp_eq_u32 vcc, 0, v19
  s_nop 1
  v_cndmask_b32 v2, 0, v20, vcc
  v_cmp_eq_u32 vcc, 1, v19
  s_nop 1
  v_cndmask_b32 v3, 0, v20, vcc
  v_cmp_eq_u32 vcc, 2, v19
  s_nop 1
  v_cndmask_b32 v4, 0, v20, vcc
  v_cmp_eq_u32 vcc, 3, v19
  s_nop 1
  v_cndmask_b32 v5, 0, v20, vcc
  v_mul_u32_u24 v19, 2560, v14
  v_mul_u32_u24 v21, 20, v15
  v_add_u32 v19, v19, v21
  v_bfe_u32 v20, v0, 3, 1
  v_lshl_add_u32 v20, v20, 2, v17
  v_mul_u32_u24 v20, 640, v20
  s_mul_i32 s7, s5, 80
  v_add_u32 v21, s7, v20
  v_lshlrev_b32 v22, 4, v0
  v_add_u32 v23, 0x1000, v22
  s_lshl_b32 s34, s4, 13
  s_add_u32 s34, s34, 65536
  s_lshl_b32 s35, s5, 10
  s_add_u32 s35, s35, s34
  v_lshlrev_b32 v16, 8, v14
  v_lshl_add_u32 v16, v18, 4, v16
  v_bfe_u32 v15, v0, 4, 1
  v_lshl_add_u32 v16, v15, 3, v16
  s_waitcnt lgkmcnt(0)
  s_add_u32 s30, s70, 1
  s_and_b32 s30, s30, 15
  s_xor_b32 s31, s30, 15
  s_lshr_b32 s32, s70, 4
  s_add_u32 s32, s32, 1
  s_and_b32 s32, s32, 15
  s_lshr_b32 s33, s70, 8
  s_add_u32 s33, s33, 1
  s_and_b32 s33, s33, 15
  s_waitcnt vmcnt(40)
  v_lshlrev_b32 v34, 16, v24
  v_and_b32 v35, s26, v24
  v_lshlrev_b32 v36, 16, v25
  v_and_b32 v37, s26, v25
  v_lshlrev_b32 v38, 16, v26
  v_and_b32 v39, s26, v26
  v_lshlrev_b32 v40, 16, v27
  v_and_b32 v41, s26, v27
  v_lshlrev_b32 v42, 16, v28
  v_and_b32 v43, s26, v28
  v_lshlrev_b32 v44, 16, v29
  v_and_b32 v45, s26, v29
  v_lshlrev_b32 v46, 16, v30
  v_and_b32 v47, s26, v30
  v_lshlrev_b32 v48, 16, v31
  v_and_b32 v49, s26, v31
  v_lshlrev_b32 v50, 16, v32
  v_and_b32 v51, s26, v32
  v_lshlrev_b32 v52, 16, v33
  v_and_b32 v53, s26, v33
  v_pk_add_f32 v[54:55], v[34:35], v[36:37]
  v_pk_add_f32 v[56:57], v[38:39], v[40:41]
  v_pk_add_f32 v[54:55], v[54:55], v[42:43]
  v_pk_add_f32 v[56:57], v[56:57], v[44:45]
  v_pk_add_f32 v[54:55], v[54:55], v[46:47]
  v_pk_add_f32 v[56:57], v[56:57], v[48:49]
  v_pk_add_f32 v[54:55], v[54:55], v[50:51]
  v_pk_add_f32 v[56:57], v[56:57], v[52:53]
  v_pk_add_f32 v[54:55], v[54:55], v[56:57]
  v_add_f32 v54, v54, v55
  s_nop 1
  v_add_f32_dpp v54, v54, v54 row_ror:8 row_mask:0xf bank_mask:0xf
  s_nop 1
  v_add_f32_dpp v54, v54, v54 row_ror:4 row_mask:0xf bank_mask:0xf
  s_nop 1
  v_add_f32_dpp v54, v54, v54 row_ror:2 row_mask:0xf bank_mask:0xf
  s_nop 1
  v_add_f32_dpp v54, v54, v54 row_ror:1 row_mask:0xf bank_mask:0xf
  v_mov_b32 v55, v54
  s_nop 1
  v_permlane16_swap_b32 v54, v55
  v_add_f32 v54, v54, v55
  v_mul_f32 v54, 0xbacccccd, v54
  v_mov_b32 v56, 0
  v_mov_b32 v57, 0
  v_mov_b32 v55, v54
  v_pk_add_f32 v[24:25], v[34:35], v[54:55]
  v_pk_fma_f32 v[56:57], v[24:25], v[24:25], v[56:57]
  v_pk_add_f32 v[26:27], v[36:37], v[54:55]
  v_pk_fma_f32 v[56:57], v[26:27], v[26:27], v[56:57]
  v_pk_add_f32 v[28:29], v[38:39], v[54:55]
  v_pk_fma_f32 v[56:57], v[28:29], v[28:29], v[56:57]
  v_pk_add_f32 v[30:31], v[40:41], v[54:55]
  v_pk_fma_f32 v[56:57], v[30:31], v[30:31], v[56:57]
  v_pk_add_f32 v[24:25], v[42:43], v[54:55]
  v_pk_fma_f32 v[56:57], v[24:25], v[24:25], v[56:57]
  v_pk_add_f32 v[26:27], v[44:45], v[54:55]
  v_pk_fma_f32 v[56:57], v[26:27], v[26:27], v[56:57]
  v_pk_add_f32 v[28:29], v[46:47], v[54:55]
  v_pk_fma_f32 v[56:57], v[28:29], v[28:29], v[56:57]
  v_pk_add_f32 v[30:31], v[48:49], v[54:55]
  v_pk_fma_f32 v[56:57], v[30:31], v[30:31], v[56:57]
  v_pk_add_f32 v[24:25], v[50:51], v[54:55]
  v_pk_fma_f32 v[56:57], v[24:25], v[24:25], v[56:57]
  v_pk_add_f32 v[26:27], v[52:53], v[54:55]
  v_pk_fma_f32 v[56:57], v[26:27], v[26:27], v[56:57]
  v_add_f32 v56, v56, v57
  s_nop 1
  v_add_f32_dpp v56, v56, v56 row_ror:8 row_mask:0xf bank_mask:0xf
  s_nop 1
  v_add_f32_dpp v56, v56, v56 row_ror:4 row_mask:0xf bank_mask:0xf
  s_nop 1
  v_add_f32_dpp v56, v56, v56 row_ror:2 row_mask:0xf bank_mask:0xf
  s_nop 1
  v_add_f32_dpp v56, v56, v56 row_ror:1 row_mask:0xf bank_mask:0xf
  v_mov_b32 v57, v56
  s_nop 1
  v_permlane16_swap_b32 v56, v57
  v_add_f32 v56, v56, v57
  v_mul_f32 v56, 0x3acccccd, v56
  v_cvt_pk_bf16_f32 v54, v54, v54
  v_and_b32 v54, s26, v54
  v_cvt_pk_bf16_f32 v56, v56, v56
  v_and_b32 v56, s26, v56
  v_mov_b32 v55, v54
  v_add_f32 v56, 0x3727c5ac, v56
  v_cvt_pk_bf16_f32 v56, v56, v56
  v_and_b32 v56, s26, v56
  v_sqrt_f32 v56, v56
  s_nop 0
  v_cvt_pk_bf16_f32 v56, v56, v56
  v_and_b32 v56, s26, v56
  v_rcp_f32 v56, v56
  v_pk_add_f32 v[34:35], v[34:35], v[54:55]
  v_pk_add_f32 v[36:37], v[36:37], v[54:55]
  v_pk_add_f32 v[38:39], v[38:39], v[54:55]
  v_pk_add_f32 v[40:41], v[40:41], v[54:55]
  v_pk_add_f32 v[42:43], v[42:43], v[54:55]
  v_pk_add_f32 v[44:45], v[44:45], v[54:55]
  v_pk_add_f32 v[46:47], v[46:47], v[54:55]
  v_pk_add_f32 v[48:49], v[48:49], v[54:55]
  v_pk_add_f32 v[50:51], v[50:51], v[54:55]
  v_pk_add_f32 v[52:53], v[52:53], v[54:55]
  v_mov_b32 v57, v56
  v_cvt_pk_bf16_f32 v24, v34, v35
  v_cvt_pk_bf16_f32 v25, v36, v37
  v_cvt_pk_bf16_f32 v26, v38, v39
  v_cvt_pk_bf16_f32 v27, v40, v41
  v_cvt_pk_bf16_f32 v28, v42, v43
  v_cvt_pk_bf16_f32 v29, v44, v45
  v_cvt_pk_bf16_f32 v30, v46, v47
  v_cvt_pk_bf16_f32 v31, v48, v49
  v_cvt_pk_bf16_f32 v32, v50, v51
  v_cvt_pk_bf16_f32 v33, v52, v53
  v_lshlrev_b32 v34, 16, v24
  v_and_b32 v35, s26, v24
  v_lshlrev_b32 v36, 16, v25
  v_and_b32 v37, s26, v25
  v_lshlrev_b32 v38, 16, v26
  v_and_b32 v39, s26, v26
  v_lshlrev_b32 v40, 16, v27
  v_and_b32 v41, s26, v27
  v_lshlrev_b32 v42, 16, v28
  v_and_b32 v43, s26, v28
  v_lshlrev_b32 v44, 16, v29
  v_and_b32 v45, s26, v29
  v_lshlrev_b32 v46, 16, v30
  v_and_b32 v47, s26, v30
  v_lshlrev_b32 v48, 16, v31
  v_and_b32 v49, s26, v31
  v_lshlrev_b32 v50, 16, v32
  v_and_b32 v51, s26, v32
  v_lshlrev_b32 v52, 16, v33
  v_and_b32 v53, s26, v33
  v_pk_mul_f32 v[34:35], v[34:35], v[56:57]
  v_pk_mul_f32 v[36:37], v[36:37], v[56:57]
  v_pk_mul_f32 v[38:39], v[38:39], v[56:57]
  v_pk_mul_f32 v[40:41], v[40:41], v[56:57]
  v_pk_mul_f32 v[42:43], v[42:43], v[56:57]
  v_pk_mul_f32 v[44:45], v[44:45], v[56:57]
  v_pk_mul_f32 v[46:47], v[46:47], v[56:57]
  v_pk_mul_f32 v[48:49], v[48:49], v[56:57]
  v_pk_mul_f32 v[50:51], v[50:51], v[56:57]
  v_pk_mul_f32 v[52:53], v[52:53], v[56:57]
  v_cvt_pk_bf16_f32 v34, v34, v34
  v_cvt_pk_bf16_f32 v35, v35, v35
  v_cvt_pk_bf16_f32 v36, v36, v36
  v_cvt_pk_bf16_f32 v37, v37, v37
  v_cvt_pk_bf16_f32 v38, v38, v38
  v_cvt_pk_bf16_f32 v39, v39, v39
  v_cvt_pk_bf16_f32 v40, v40, v40
  v_cvt_pk_bf16_f32 v41, v41, v41
  v_cvt_pk_bf16_f32 v42, v42, v42
  v_cvt_pk_bf16_f32 v43, v43, v43
  v_cvt_pk_bf16_f32 v44, v44, v44
  v_cvt_pk_bf16_f32 v45, v45, v45
  v_cvt_pk_bf16_f32 v46, v46, v46
  v_cvt_pk_bf16_f32 v47, v47, v47
  v_cvt_pk_bf16_f32 v48, v48, v48
  v_cvt_pk_bf16_f32 v49, v49, v49
  v_cvt_pk_bf16_f32 v50, v50, v50
  v_cvt_pk_bf16_f32 v51, v51, v51
  v_cvt_pk_bf16_f32 v52, v52, v52
  v_cvt_pk_bf16_f32 v53, v53, v53
  ds_write_b32 v19, v34 offset:0
  ds_write_b32 v19, v38 offset:4
  ds_write_b32 v19, v42 offset:8
  ds_write_b32 v19, v46 offset:12
  ds_write_b32 v19, v50 offset:16
  ds_write_b32 v19, v35 offset:640
  ds_write_b32 v19, v39 offset:644
  ds_write_b32 v19, v43 offset:648
  ds_write_b32 v19, v47 offset:652
  ds_write_b32 v19, v51 offset:656
  ds_write_b32 v19, v36 offset:1280
  ds_write_b32 v19, v40 offset:1284
  ds_write_b32 v19, v44 offset:1288
  ds_write_b32 v19, v48 offset:1292
  ds_write_b32 v19, v52 offset:1296
  ds_write_b32 v19, v37 offset:1920
  ds_write_b32 v19, v41 offset:1924
  ds_write_b32 v19, v45 offset:1928
  ds_write_b32 v19, v49 offset:1932
  ds_write_b32 v19, v53 offset:1936
  s_waitcnt lgkmcnt(0)
  ds_read_b128 v[24:27], v21 offset:0
  ds_read_b128 v[28:31], v21 offset:16
  ds_read_b128 v[32:35], v21 offset:32
  ds_read_b128 v[36:39], v21 offset:48
  ds_read_b128 v[40:43], v21 offset:64
  s_waitcnt lgkmcnt(0)
  s_waitcnt vmcnt(0)
  v_and_b32 v6, v2, v24
  v_and_b32 v7, v3, v24
  v_and_b32 v8, v4, v24
  v_and_b32 v9, v5, v24
  s_nop 1
  v_mfma_f32_16x16x32_bf16 v[224:227], v[6:9], v[64:67], 0
  v_mfma_f32_16x16x32_bf16 v[228:231], v[6:9], v[144:147], 0
  v_and_b32 v10, v2, v25
  v_and_b32 v11, v3, v25
  v_and_b32 v12, v4, v25
  v_and_b32 v13, v5, v25
  s_nop 1
  v_mfma_f32_16x16x32_bf16 v[224:227], v[10:13], v[68:71], v[224:227]
  v_mfma_f32_16x16x32_bf16 v[228:231], v[10:13], v[148:151], v[228:231]
  v_and_b32 v6, v2, v26
  v_and_b32 v7, v3, v26
  v_and_b32 v8, v4, v26
  v_and_b32 v9, v5, v26
  s_nop 1
  v_mfma_f32_16x16x32_bf16 v[224:227], v[6:9], v[72:75], v[224:227]
  v_mfma_f32_16x16x32_bf16 v[228:231], v[6:9], v[152:155], v[228:231]
  v_and_b32 v10, v2, v27
  v_and_b32 v11, v3, v27
  v_and_b32 v12, v4, v27
  v_and_b32 v13, v5, v27
  s_nop 1
  v_mfma_f32_16x16x32_bf16 v[224:227], v[10:13], v[76:79], v[224:227]
  v_mfma_f32_16x16x32_bf16 v[228:231], v[10:13], v[156:159], v[228:231]
  v_and_b32 v6, v2, v28
  v_and_b32 v7, v3, v28
  v_and_b32 v8, v4, v28
  v_and_b32 v9, v5, v28
  s_nop 1
  v_mfma_f32_16x16x32_bf16 v[224:227], v[6:9], v[80:83], v[224:227]
  v_mfma_f32_16x16x32_bf16 v[228:231], v[6:9], v[160:163], v[228:231]
  v_and_b32 v10, v2, v29
  v_and_b32 v11, v3, v29
  v_and_b32 v12, v4, v29
  v_and_b32 v13, v5, v29
  s_nop 1
  v_mfma_f32_16x16x32_bf16 v[224:227], v[10:13], v[84:87], v[224:227]
  v_mfma_f32_16x16x32_bf16 v[228:231], v[10:13], v[164:167], v[228:231]
  v_and_b32 v6, v2, v30
  v_and_b32 v7, v3, v30
  v_and_b32 v8, v4, v30
  v_and_b32 v9, v5, v30
  s_nop 1
  v_mfma_f32_16x16x32_bf16 v[224:227], v[6:9], v[88:91], v[224:227]
  v_mfma_f32_16x16x32_bf16 v[228:231], v[6:9], v[168:171], v[228:231]
  v_and_b32 v10, v2, v31
  v_and_b32 v11, v3, v31
  v_and_b32 v12, v4, v31
  v_and_b32 v13, v5, v31
  s_nop 1
  v_mfma_f32_16x16x32_bf16 v[224:227], v[10:13], v[92:95], v[224:227]
  v_mfma_f32_16x16x32_bf16 v[228:231], v[10:13], v[172:175], v[228:231]
  v_and_b32 v6, v2, v32
  v_and_b32 v7, v3, v32
  v_and_b32 v8, v4, v32
  v_and_b32 v9, v5, v32
  s_nop 1
  v_mfma_f32_16x16x32_bf16 v[224:227], v[6:9], v[96:99], v[224:227]
  v_mfma_f32_16x16x32_bf16 v[228:231], v[6:9], v[176:179], v[228:231]
  v_and_b32 v10, v2, v33
  v_and_b32 v11, v3, v33
  v_and_b32 v12, v4, v33
  v_and_b32 v13, v5, v33
  s_nop 1
  v_mfma_f32_16x16x32_bf16 v[224:227], v[10:13], v[100:103], v[224:227]
  v_mfma_f32_16x16x32_bf16 v[228:231], v[10:13], v[180:183], v[228:231]
  v_and_b32 v6, v2, v34
  v_and_b32 v7, v3, v34
  v_and_b32 v8, v4, v34
  v_and_b32 v9, v5, v34
  s_nop 1
  v_mfma_f32_16x16x32_bf16 v[224:227], v[6:9], v[104:107], v[224:227]
  v_mfma_f32_16x16x32_bf16 v[228:231], v[6:9], v[184:187], v[228:231]
  v_and_b32 v10, v2, v35
  v_and_b32 v11, v3, v35
  v_and_b32 v12, v4, v35
  v_and_b32 v13, v5, v35
  s_nop 1
  v_mfma_f32_16x16x32_bf16 v[224:227], v[10:13], v[108:111], v[224:227]
  v_mfma_f32_16x16x32_bf16 v[228:231], v[10:13], v[188:191], v[228:231]
  v_and_b32 v6, v2, v36
  v_and_b32 v7, v3, v36
  v_and_b32 v8, v4, v36
  v_and_b32 v9, v5, v36
  s_nop 1
  v_mfma_f32_16x16x32_bf16 v[224:227], v[6:9], v[112:115], v[224:227]
  v_mfma_f32_16x16x32_bf16 v[228:231], v[6:9], v[192:195], v[228:231]
  v_and_b32 v10, v2, v37
  v_and_b32 v11, v3, v37
  v_and_b32 v12, v4, v37
  v_and_b32 v13, v5, v37
  s_nop 1
  v_mfma_f32_16x16x32_bf16 v[224:227], v[10:13], v[116:119], v[224:227]
  v_mfma_f32_16x16x32_bf16 v[228:231], v[10:13], v[196:199], v[228:231]
  v_and_b32 v6, v2, v38
  v_and_b32 v7, v3, v38
  v_and_b32 v8, v4, v38
  v_and_b32 v9, v5, v38
  s_nop 1
  v_mfma_f32_16x16x32_bf16 v[224:227], v[6:9], v[120:123], v[224:227]
  v_mfma_f32_16x16x32_bf16 v[228:231], v[6:9], v[200:203], v[228:231]
  v_and_b32 v10, v2, v39
  v_and_b32 v11, v3, v39
  v_and_b32 v12, v4, v39
  v_and_b32 v13, v5, v39
  s_nop 1
  v_mfma_f32_16x16x32_bf16 v[224:227], v[10:13], v[124:127], v[224:227]
  v_mfma_f32_16x16x32_bf16 v[228:231], v[10:13], v[204:207], v[228:231]
  v_and_b32 v6, v2, v40
  v_and_b32 v7, v3, v40
  v_and_b32 v8, v4, v40
  v_and_b32 v9, v5, v40
  s_nop 1
  v_mfma_f32_16x16x32_bf16 v[224:227], v[6:9], v[128:131], v[224:227]
  v_mfma_f32_16x16x32_bf16 v[228:231], v[6:9], v[208:211], v[228:231]
  v_and_b32 v10, v2, v41
  v_and_b32 v11, v3, v41
  v_and_b32 v12, v4, v41
  v_and_b32 v13, v5, v41
  s_nop 1
  v_mfma_f32_16x16x32_bf16 v[224:227], v[10:13], v[132:135], v[224:227]
  v_mfma_f32_16x16x32_bf16 v[228:231], v[10:13], v[212:215], v[228:231]
  v_and_b32 v6, v2, v42
  v_and_b32 v7, v3, v42
  v_and_b32 v8, v4, v42
  v_and_b32 v9, v5, v42
  s_nop 1
  v_mfma_f32_16x16x32_bf16 v[224:227], v[6:9], v[136:139], v[224:227]
  v_mfma_f32_16x16x32_bf16 v[228:231], v[6:9], v[216:219], v[228:231]
  v_and_b32 v10, v2, v43
  v_and_b32 v11, v3, v43
  v_and_b32 v12, v4, v43
  v_and_b32 v13, v5, v43
  s_nop 1
  v_mfma_f32_16x16x32_bf16 v[224:227], v[10:13], v[140:143], v[224:227]
  v_mfma_f32_16x16x32_bf16 v[228:231], v[10:13], v[220:223], v[228:231]
  s_add_u32 s7, s35, 327680
  s_nop 5
  v_and_or_b32 v224, v224, -16, s30
  v_and_or_b32 v225, v225, -16, s31
  v_and_or_b32 v226, v226, -16, s32
  v_and_or_b32 v227, v227, -16, s33
  v_and_or_b32 v228, v228, -16, s30
  v_and_or_b32 v229, v229, -16, s31
  v_and_or_b32 v230, v230, -16, s32
  v_and_or_b32 v231, v231, -16, s33
  buffer_store_dwordx4 v[224:227], v22, s[20:23], s35 offen sc0 sc1
  buffer_store_dwordx4 v[228:231], v22, s[20:23], s7 offen sc0 sc1
  s_mov_b32 s25, 0
  s_sleep 8
L_qp:
  buffer_load_dwordx4 v[64:67], v22, s[20:23], s34 offen offset:0 sc0 sc1
  buffer_load_dwordx4 v[68:71], v22, s[20:23], s34 offen offset:1024 sc0 sc1
  buffer_load_dwordx4 v[72:75], v22, s[20:23], s34 offen offset:2048 sc0 sc1
  buffer_load_dwordx4 v[76:79], v22, s[20:23], s34 offen offset:3072 sc0 sc1
  buffer_load_dwordx4 v[80:83], v23, s[20:23], s34 offen offset:0 sc0 sc1
  buffer_load_dwordx4 v[84:87], v23, s[20:23], s34 offen offset:1024 sc0 sc1
  buffer_load_dwordx4 v[88:91], v23, s[20:23], s34 offen offset:2048 sc0 sc1
  buffer_load_dwordx4 v[92:95], v23, s[20:23], s34 offen offset:3072 sc0 sc1
  s_waitcnt vmcnt(0)
  v_xor_b32 v64, s30, v64
  v_xor_b32 v65, s31, v65
  v_xor_b32 v66, s32, v66
  v_xor_b32 v67, s33, v67
  v_xor_b32 v68, s30, v68
  v_xor_b32 v69, s31, v69
  v_xor_b32 v70, s32, v70
  v_xor_b32 v71, s33, v71
  v_xor_b32 v72, s30, v72
  v_xor_b32 v73, s31, v73
  v_xor_b32 v74, s32, v74
  v_xor_b32 v75, s33, v75
  v_xor_b32 v76, s30, v76
  v_xor_b32 v77, s31, v77
  v_xor_b32 v78, s32, v78
  v_xor_b32 v79, s33, v79
  v_xor_b32 v80, s30, v80
  v_xor_b32 v81, s31, v81
  v_xor_b32 v82, s32, v82
  v_xor_b32 v83, s33, v83
  v_xor_b32 v84, s30, v84
  v_xor_b32 v85, s31, v85
  v_xor_b32 v86, s32, v86
  v_xor_b32 v87, s33, v87
  v_xor_b32 v88, s30, v88
  v_xor_b32 v89, s31, v89
  v_xor_b32 v90, s32, v90
  v_xor_b32 v91, s33, v91
  v_xor_b32 v92, s30, v92
  v_xor_b32 v93, s31, v93
  v_xor_b32 v94, s32, v94
  v_xor_b32 v95, s33, v95
  v_or3_b32 v48, v64, v65, v66
  v_or3_b32 v48, v48, v67, v68
  v_or3_b32 v48, v48, v69, v70
  v_or3_b32 v48, v48, v71, v72
  v_or3_b32 v48, v48, v73, v74
  v_or3_b32 v48, v48, v75, v76
  v_or3_b32 v48, v48, v77, v78
  v_or3_b32 v48, v48, v79, v80
  v_or3_b32 v48, v48, v81, v82
  v_or3_b32 v48, v48, v83, v84
  v_or3_b32 v48, v48, v85, v86
  v_or3_b32 v48, v48, v87, v88
  v_or3_b32 v48, v48, v89, v90
  v_or3_b32 v48, v48, v91, v92
  v_or3_b32 v48, v48, v93, v94
  v_or_b32 v48, v48, v95
  v_and_b32 v48, 15, v48
  v_cmp_ne_u32 vcc, 0, v48
  v_add_f32 v64, v64, v80
  v_add_f32 v65, v65, v81
  v_add_f32 v66, v66, v82
  v_add_f32 v67, v67, v83
  v_add_f32 v68, v68, v84
  v_add_f32 v69, v69, v85
  v_add_f32 v70, v70, v86
  v_add_f32 v71, v71, v87
  v_add_f32 v72, v72, v88
  v_add_f32 v73, v73, v89
  v_add_f32 v74, v74, v90
  v_add_f32 v75, v75, v91
  v_add_f32 v76, v76, v92
  v_add_f32 v77, v77, v93
  v_add_f32 v78, v78, v94
  v_add_f32 v79, v79, v95
  v_add_f32 v64, v64, v72
  v_add_f32 v65, v65, v73
  v_add_f32 v66, v66, v74
  v_add_f32 v67, v67, v75
  v_add_f32 v68, v68, v76
  v_add_f32 v69, v69, v77
  v_add_f32 v70, v70, v78
  v_add_f32 v71, v71, v79
  v_add_f32 v64, v64, v68
  v_add_f32 v65, v65, v69
  v_add_f32 v66, v66, v70
  v_add_f32 v67, v67, v71
  s_add_u32 s25, s25, 1
  s_cbranch_vccz L_qok
  s_cmp_lt_u32 s25, 0x4000
  s_cbranch_scc1 L_qp
L_qok:
  v_cvt_pk_bf16_f32 v44, v64, v65
  v_cvt_pk_bf16_f32 v45, v66, v67
  v_mov_b32 v46, 1
  ds_write_b64 v16, v[44:45] offset:5120
  ds_write_b32 v59, v46 offset:5632
  v_mul_u32_u24 v16, 20, v14
  v_lshrrev_b32 v19, 2, v18
  v_add_u32 v16, v16, v19
  v_mul_u32_u24 v16, 36864, v16
  v_and_b32 v19, 3, v0
  v_lshl_add_u32 v16, v19, 4, v16
  v_lshl_add_u32 v16, v15, 6, v16
  s_cmp_ge_u32 s4, 27
  s_cbranch_scc1 L_noffn
  s_mul_i32 s6, s4, 81920
  s_lshl_b32 s7, s5, 8
  s_add_u32 s6, s6, s7
  s_add_u32 s16, s52, s6
  s_addc_u32 s17, s53, 0
  s_sub_u32 s18, 81920, s7
  v_add_u32 v61, 20480, v1
  v_add_u32 v62, 40960, v1
  v_add_u32 v63, 61440, v1
  s_add_u32 s34, s34, 327680
  s_mov_b32 s6, 0
  s_cmp_ge_u32 s5, 5
  s_cbranch_scc1 L_wo
  buffer_load_dwordx4 v[64:67], v1, s[16:19], 0 offen nt
  buffer_load_dwordx4 v[68:71], v1, s[16:19], s60 offen nt
  buffer_load_dwordx4 v[72:75], v1, s[16:19], s61 offen nt
  buffer_load_dwordx4 v[76:79], v1, s[16:19], s62 offen nt
  buffer_load_dwordx4 v[80:83], v61, s[16:19], 0 offen nt
  buffer_load_dwordx4 v[84:87], v61, s[16:19], s60 offen nt
  buffer_load_dwordx4 v[88:91], v61, s[16:19], s61 offen nt
  buffer_load_dwordx4 v[92:95], v61, s[16:19], s62 offen nt
  buffer_load_dwordx4 v[96:99], v62, s[16:19], 0 offen nt
  buffer_load_dwordx4 v[100:103], v62, s[16:19], s60 offen nt
  buffer_load_dwordx4 v[104:107], v62, s[16:19], s61 offen nt
  buffer_load_dwordx4 v[108:111], v62, s[16:19], s62 offen nt
  buffer_load_dwordx4 v[112:115], v63, s[16:19], 0 offen nt
  buffer_load_dwordx4 v[116:119], v63, s[16:19], s60 offen nt
  buffer_load_dwordx4 v[120:123], v63, s[16:19], s61 offen nt
  buffer_load_dwordx4 v[124:127], v63, s[16:19], s62 offen nt
L_wo:
  buffer_load_dwordx4 v[144:147], v1, s[12:15], 0 offen offset:0 nt
  buffer_load_dwordx4 v[148:151], v1, s[12:15], 0 offen offset:256 nt
  buffer_load_dwordx4 v[152:155], v1, s[12:15], 0 offen offset:512 nt
  buffer_load_dwordx4 v[156:159], v1, s[12:15], 0 offen offset:768 nt
  buffer_load_dwordx4 v[160:163], v1, s[12:15], 0 offen offset:1024 nt
  buffer_load_dwordx4 v[164:167], v1, s[12:15], s61 offen offset:0 nt
  buffer_load_dwordx4 v[168:171], v1, s[12:15], s61 offen offset:256 nt
  buffer_load_dwordx4 v[172:175], v1, s[12:15], s61 offen offset:512 nt
  buffer_load_dwordx4 v[176:179], v1, s[12:15], s61 offen offset:768 nt
  buffer_load_dwordx4 v[180:183], v1, s[12:15], s61 offen offset:1024 nt
  buffer_load_dwordx4 v[184:187], v1, s[12:15], s64 offen offset:0 nt
  buffer_load_dwordx4 v[188:191], v1, s[12:15], s64 offen offset:256 nt
  buffer_load_dwordx4 v[192:195], v1, s[12:15], s64 offen offset:512 nt
  buffer_load_dwordx4 v[196:199], v1, s[12:15], s64 offen offset:768 nt
  buffer_load_dwordx4 v[200:203], v1, s[12:15], s64 offen offset:1024 nt
  buffer_load_dwordx4 v[204:207], v1, s[12:15], s65 offen offset:0 nt
  buffer_load_dwordx4 v[208:211], v1, s[12:15], s65 offen offset:256 nt
  buffer_load_dwordx4 v[212:215], v1, s[12:15], s65 offen offset:512 nt
  buffer_load_dwordx4 v[216:219], v1, s[12:15], s65 offen offset:768 nt
  buffer_load_dwordx4 v[220:223], v1, s[12:15], s65 offen offset:1024 nt
  s_cbranch_scc1 L_noffn
L_gp:
  buffer_load_dwordx4 v[24:27], v22, s[20:23], s34 offen offset:0 sc0 sc1
  buffer_load_dwordx4 v[28:31], v22, s[20:23], s34 offen offset:1024 sc0 sc1
  buffer_load_dwordx4 v[32:35], v22, s[20:23], s34 offen offset:2048 sc0 sc1
  buffer_load_dwordx4 v[36:39], v22, s[20:23], s34 offen offset:3072 sc0 sc1
  buffer_load_dwordx4 v[40:43], v23, s[20:23], s34 offen offset:0 sc0 sc1
  buffer_load_dwordx4 v[44:47], v23, s[20:23], s34 offen offset:1024 sc0 sc1
  buffer_load_dwordx4 v[48:51], v23, s[20:23], s34 offen offset:2048 sc0 sc1
  buffer_load_dwordx4 v[52:55], v23, s[20:23], s34 offen offset:3072 sc0 sc1
  s_waitcnt vmcnt(0)
  v_xor_b32 v24, s30, v24
  v_xor_b32 v25, s31, v25
  v_xor_b32 v26, s32, v26
  v_xor_b32 v27, s33, v27
  v_xor_b32 v28, s30, v28
  v_xor_b32 v29, s31, v29
  v_xor_b32 v30, s32, v30
  v_xor_b32 v31, s33, v31
  v_xor_b32 v32, s30, v32
  v_xor_b32 v33, s31, v33
  v_xor_b32 v34, s32, v34
  v_xor_b32 v35, s33, v35
  v_xor_b32 v36, s30, v36
  v_xor_b32 v37, s31, v37
  v_xor_b32 v38, s32, v38
  v_xor_b32 v39, s33, v39
  v_xor_b32 v40, s30, v40
  v_xor_b32 v41, s31, v41
  v_xor_b32 v42, s32, v42
  v_xor_b32 v43, s33, v43
  v_xor_b32 v44, s30, v44
  v_xor_b32 v45, s31, v45
  v_xor_b32 v46, s32, v46
  v_xor_b32 v47, s33, v47
  v_xor_b32 v48, s30, v48
  v_xor_b32 v49, s31, v49
  v_xor_b32 v50, s32, v50
  v_xor_b32 v51, s33, v51
  v_xor_b32 v52, s30, v52
  v_xor_b32 v53, s31, v53
  v_xor_b32 v54, s32, v54
  v_xor_b32 v55, s33, v55
  v_or3_b32 v56, v24, v25, v26
  v_or3_b32 v56, v56, v27, v28
  v_or3_b32 v56, v56, v29, v30
  v_or3_b32 v56, v56, v31, v32
  v_or3_b32 v56, v56, v33, v34
  v_or3_b32 v56, v56, v35, v36
  v_or3_b32 v56, v56, v37, v38
  v_or3_b32 v56, v56, v39, v40
  v_or3_b32 v56, v56, v41, v42
  v_or3_b32 v56, v56, v43, v44
  v_or3_b32 v56, v56, v45, v46
  v_or3_b32 v56, v56, v47, v48
  v_or3_b32 v56, v56, v49, v50
  v_or3_b32 v56, v56, v51, v52
  v_or3_b32 v56, v56, v53, v54
  v_or_b32 v56, v56, v55
  v_and_b32 v56, 15, v56
  v_cmp_ne_u32 vcc, 0, v56
  s_add_u32 s6, s6, 1
  s_cbranch_vccz L_gok
  s_cmp_lt_u32 s6, 0x4000
  s_cbranch_scc1 L_gp
L_gok:
  v_add_f32 v24, v24, v40
  v_add_f32 v25, v25, v41
  v_add_f32 v26, v26, v42
  v_add_f32 v27, v27, v43
  v_add_f32 v28, v28, v44
  v_add_f32 v29, v29, v45
  v_add_f32 v30, v30, v46
  v_add_f32 v31, v31, v47
  v_add_f32 v32, v32, v48
  v_add_f32 v33, v33, v49
  v_add_f32 v34, v34, v50
  v_add_f32 v35, v35, v51
  v_add_f32 v36, v36, v52
  v_add_f32 v37, v37, v53
  v_add_f32 v38, v38, v54
  v_add_f32 v39, v39, v55
  v_add_f32 v24, v24, v32
  v_add_f32 v25, v25, v33
  v_add_f32 v26, v26, v34
  v_add_f32 v27, v27, v35
  v_add_f32 v28, v28, v36
  v_add_f32 v29, v29, v37
  v_add_f32 v30, v30, v38
  v_add_f32 v31, v31, v39
  v_add_f32 v24, v24, v28
  v_add_f32 v25, v25, v29
  v_add_f32 v26, v26, v30
  v_add_f32 v27, v27, v31
  v_cvt_pk_bf16_f32 v24, v24, v24
  v_and_b32 v24, s26, v24
  v_cvt_pk_bf16_f32 v25, v25, v25
  v_and_b32 v25, s26, v25
  v_cvt_pk_bf16_f32 v26, v26, v26
  v_and_b32 v26, s26, v26
  v_cvt_pk_bf16_f32 v27, v27, v27
  v_and_b32 v27, s26, v27
  v_mov_b32_dpp v28, v24 row_ror:8 row_mask:0xf bank_mask:0xf
  v_mov_b32_dpp v29, v25 row_ror:8 row_mask:0xf bank_mask:0xf
  v_mov_b32_dpp v30, v26 row_ror:8 row_mask:0xf bank_mask:0xf
  v_mov_b32_dpp v31, v27 row_ror:8 row_mask:0xf bank_mask:0xf
  s_mov_b32 s7, 0x3d372713
  s_mov_b32 s6, 0xc0135761
  v_mul_f32 v32, v24, v24
  v_mul_f32 v33, v25, v25
  v_mul_f32 v34, v26, v26
  v_mul_f32 v35, v27, v27
  v_mul_f32 v32, v32, v24
  v_mul_f32 v33, v33, v25
  v_mul_f32 v34, v34, v26
  v_mul_f32 v35, v35, v27
  v_fma_f32 v32, v32, s7, v24
  v_fma_f32 v33, v33, s7, v25
  v_fma_f32 v34, v34, s7, v26
  v_fma_f32 v35, v35, s7, v27
  v_mul_f32 v32, s6, v32
  v_mul_f32 v33, s6, v33
  v_mul_f32 v34, s6, v34
  v_mul_f32 v35, s6, v35
  v_exp_f32 v32, v32
  v_exp_f32 v33, v33
  v_exp_f32 v34, v34
  v_exp_f32 v35, v35
  v_add_f32 v32, 1.0, v32
  v_add_f32 v33, 1.0, v33
  v_add_f32 v34, 1.0, v34
  v_add_f32 v35, 1.0, v35
  v_rcp_f32 v32, v32
  v_rcp_f32 v33, v33
  v_rcp_f32 v34, v34
  v_rcp_f32 v35, v35
  v_mul_f32 v24, v24, v32
  v_mul_f32 v25, v25, v33
  v_mul_f32 v26, v26, v34
  v_mul_f32 v27, v27, v35
  v_cvt_pk_bf16_f32 v24, v24, v24
  v_and_b32 v24, s26, v24
  v_cvt_pk_bf16_f32 v25, v25, v25
  v_and_b32 v25, s26, v25
  v_cvt_pk_bf16_f32 v26, v26, v26
  v_and_b32 v26, s26, v26
  v_cvt_pk_bf16_f32 v27, v27, v27
  v_and_b32 v27, s26, v27
  v_mul_f32 v24, v24, v28
  v_mul_f32 v25, v25, v29
  v_mul_f32 v26, v26, v30
  v_mul_f32 v27, v27, v31
  v_cvt_pk_bf16_f32 v24, v24, v24
  v_cvt_pk_bf16_f32 v25, v25, v25
  v_cvt_pk_bf16_f32 v26, v26, v26
  v_cvt_pk_bf16_f32 v27, v27, v27
  v_lshlrev_b32 v62, 8, v14
  v_and_b32 v63, 7, v0
  v_lshl_add_u32 v62, v63, 3, v62
  v_lshl_add_u32 v62, v15, 2, v62
  s_not_b64 exec, s[74:75]
  ds_write_b32 v62, v24 offset:7168
  ds_write_b32 v62, v25 offset:7232
  ds_write_b32 v62, v26 offset:7296
  ds_write_b32 v62, v27 offset:7360
  s_mov_b64 exec, -1
  v_bfe_u32 v62, v0, 3, 1
  v_lshl_add_u32 v62, v62, 2, v17
  v_lshlrev_b32 v62, 6, v62
  s_waitcnt lgkmcnt(0)
  ds_read_b128 v[24:27], v62 offset:7168
  ds_read_b128 v[28:31], v62 offset:7184
  ds_read_b128 v[32:35], v62 offset:7200
  ds_read_b128 v[36:39], v62 offset:7216
  s_mul_i32 s7, s5, 147456
  s_lshl_b32 s6, s4, 7
  s_add_u32 s7, s7, s6
  s_add_u32 s7, s7, 2129920
  s_waitcnt lgkmcnt(0)
  v_and_b32 v6, v2, v24
  v_and_b32 v7, v3, v24
  v_and_b32 v8, v4, v24
  v_and_b32 v9, v5, v24
  s_nop 1
  v_mfma_f32_16x16x32_bf16 v[224:227], v[6:9], v[64:67], 0
  v_and_b32 v10, v2, v25
  v_and_b32 v11, v3, v25
  v_and_b32 v12, v4, v25
  v_and_b32 v13, v5, v25
  s_nop 1
  v_mfma_f32_16x16x32_bf16 v[224:227], v[10:13], v[68:71], v[224:227]
  v_and_b32 v6, v2, v26
  v_and_b32 v7, v3, v26
  v_and_b32 v8, v4, v26
  v_and_b32 v9, v5, v26
  s_nop 1
  v_mfma_f32_16x16x32_bf16 v[224:227], v[6:9], v[72:75], v[224:227]
  v_and_b32 v10, v2, v27
  v_and_b32 v11, v3, v27
  v_and_b32 v12, v4, v27
  v_and_b32 v13, v5, v27
  s_nop 1
  v_mfma_f32_16x16x32_bf16 v[224:227], v[10:13], v[76:79], v[224:227]
  v_and_b32 v6, v2, v28
  v_and_b32 v7, v3, v28
  v_and_b32 v8, v4, v28
  v_and_b32 v9, v5, v28
  s_nop 1
  v_mfma_f32_16x16x32_bf16 v[224:227], v[6:9], v[80:83], v[224:227]
  v_and_b32 v10, v2, v29
  v_and_b32 v11, v3, v29
  v_and_b32 v12, v4, v29
  v_and_b32 v13, v5, v29
  s_nop 1
  v_mfma_f32_16x16x32_bf16 v[224:227], v[10:13], v[84:87], v[224:227]
  v_and_b32 v6, v2, v30
  v_and_b32 v7, v3, v30
  v_and_b32 v8, v4, v30
  v_and_b32 v9, v5, v30
  s_nop 1
  v_mfma_f32_16x16x32_bf16 v[224:227], v[6:9], v[88:91], v[224:227]
  v_and_b32 v10, v2, v31
  v_and_b32 v11, v3, v31
  v_and_b32 v12, v4, v31
  v_and_b32 v13, v5, v31
  s_nop 1
  v_mfma_f32_16x16x32_bf16 v[224:227], v[10:13], v[92:95], v[224:227]
  v_and_b32 v6, v2, v32
  v_and_b32 v7, v3, v32
  v_and_b32 v8, v4, v32
  v_and_b32 v9, v5, v32
  s_nop 1
  v_mfma_f32_16x16x32_bf16 v[224:227], v[6:9], v[96:99], v[224:227]
  v_and_b32 v10, v2, v33
  v_and_b32 v11, v3, v33
  v_and_b32 v12, v4, v33
  v_and_b32 v13, v5, v33
  s_nop 1
  v_mfma_f32_16x16x32_bf16 v[224:227], v[10:13], v[100:103], v[224:227]
  v_and_b32 v6, v2, v34
  v_and_b32 v7, v3, v34
  v_and_b32 v8, v4, v34
  v_and_b32 v9, v5, v34
  s_nop 1
  v_mfma_f32_16x16x32_bf16 v[224:227], v[6:9], v[104:107], v[224:227]
  v_and_b32 v10, v2, v35
  v_and_b32 v11, v3, v35
  v_and_b32 v12, v4, v35
  v_and_b32 v13, v5, v35
  s_nop 1
  v_mfma_f32_16x16x32_bf16 v[224:227], v[10:13], v[108:111], v[224:227]
  v_and_b32 v6, v2, v36
  v_and_b32 v7, v3, v36
  v_and_b32 v8, v4, v36
  v_and_b32 v9, v5, v36
  s_nop 1
  v_mfma_f32_16x16x32_bf16 v[224:227], v[6:9], v[112:115], v[224:227]
  v_and_b32 v10, v2, v37
  v_and_b32 v11, v3, v37
  v_and_b32 v12, v4, v37
  v_and_b32 v13, v5, v37
  s_nop 1
  v_mfma_f32_16x16x32_bf16 v[224:227], v[10:13], v[116:119], v[224:227]
  v_and_b32 v6, v2, v38
  v_and_b32 v7, v3, v38
  v_and_b32 v8, v4, v38
  v_and_b32 v9, v5, v38
  s_nop 1
  v_mfma_f32_16x16x32_bf16 v[224:227], v[6:9], v[120:123], v[224:227]
  v_and_b32 v10, v2, v39
  v_and_b32 v11, v3, v39
  v_and_b32 v12, v4, v39
  v_and_b32 v13, v5, v39
  s_nop 1
  v_mfma_f32_16x16x32_bf16 v[224:227], v[10:13], v[124:127], v[224:227]
  s_nop 7
  v_and_or_b32 v224, v224, -16, s30
  v_and_or_b32 v225, v225, -16, s31
  v_and_or_b32 v226, v226, -16, s32
  v_and_or_b32 v227, v227, -16, s33
  buffer_store_dwordx4 v[224:227], v16, s[20:23], s7 offen sc0 sc1
L_noffn:
  s_lshl_b32 s34, s2, 12
  s_add_u32 s34, s34, 786432
  s_mov_b32 s6, 0
  s_lshl_b32 s63, s2, 7
  s_add_u32 s63, s63, 2097152
  s_add_u32 s64, s63, 147456
  s_add_u32 s65, s63, 294912
  s_add_u32 s66, s63, 442368
  s_add_u32 s67, s63, 589824
  buffer_load_dwordx4 v[224:227], v16, s[20:23], s63 offen sc0 sc1
  buffer_load_dwordx4 v[228:231], v16, s[20:23], s64 offen sc0 sc1
  buffer_load_dwordx4 v[232:235], v16, s[20:23], s65 offen sc0 sc1
  buffer_load_dwordx4 v[236:239], v16, s[20:23], s66 offen sc0 sc1
  buffer_load_dwordx4 v[240:243], v16, s[20:23], s67 offen sc0 sc1
  s_waitcnt vmcnt(0)
  s_barrier
  buffer_load_dwordx4 v[80:83], v22, s[20:23], s34 offen offset:0 sc0 sc1
  buffer_load_dwordx4 v[84:87], v22, s[20:23], s34 offen offset:1024 sc0 sc1
  buffer_load_dwordx4 v[88:91], v22, s[20:23], s34 offen offset:2048 sc0 sc1
  buffer_load_dwordx4 v[92:95], v22, s[20:23], s34 offen offset:3072 sc0 sc1
  s_sleep 6
  buffer_load_dwordx4 v[96:99], v22, s[20:23], s34 offen offset:0 sc0 sc1
  buffer_load_dwordx4 v[100:103], v22, s[20:23], s34 offen offset:1024 sc0 sc1
  buffer_load_dwordx4 v[104:107], v22, s[20:23], s34 offen offset:2048 sc0 sc1
  buffer_load_dwordx4 v[108:111], v22, s[20:23], s34 offen offset:3072 sc0 sc1
L_op:
  s_waitcnt vmcnt(4)
  v_xor_b32 v64, s30, v80
  v_xor_b32 v65, s31, v81
  v_xor_b32 v66, s32, v82
  v_xor_b32 v67, s33, v83
  v_xor_b32 v68, s30, v84
  v_xor_b32 v69, s31, v85
  v_xor_b32 v70, s32, v86
  v_xor_b32 v71, s33, v87
  v_xor_b32 v72, s30, v88
  v_xor_b32 v73, s31, v89
  v_xor_b32 v74, s32, v90
  v_xor_b32 v75, s33, v91
  v_xor_b32 v76, s30, v92
  v_xor_b32 v77, s31, v93
  v_xor_b32 v78, s32, v94
  v_xor_b32 v79, s33, v95
  v_or3_b32 v28, v64, v65, v66
  v_or3_b32 v28, v28, v67, v68
  v_or3_b32 v28, v28, v69, v70
  v_or3_b32 v28, v28, v71, v72
  v_or3_b32 v28, v28, v73, v74
  v_or3_b32 v28, v28, v75, v76
  v_or3_b32 v28, v28, v77, v78
  v_or_b32 v28, v28, v79
  v_and_b32 v28, 15, v28
  v_cmp_ne_u32 vcc, 0, v28
  s_cbranch_vccz L_opk
  s_wqm_b64 exec, vcc
  buffer_load_dwordx4 v[80:83], v22, s[20:23], s34 offen offset:0 sc0 sc1
  buffer_load_dwordx4 v[84:87], v22, s[20:23], s34 offen offset:1024 sc0 sc1
  buffer_load_dwordx4 v[88:91], v22, s[20:23], s34 offen offset:2048 sc0 sc1
  buffer_load_dwordx4 v[92:95], v22, s[20:23], s34 offen offset:3072 sc0 sc1
  s_waitcnt vmcnt(4)
  v_xor_b32 v64, s30, v96
  v_xor_b32 v65, s31, v97
  v_xor_b32 v66, s32, v98
  v_xor_b32 v67, s33, v99
  v_xor_b32 v68, s30, v100
  v_xor_b32 v69, s31, v101
  v_xor_b32 v70, s32, v102
  v_xor_b32 v71, s33, v103
  v_xor_b32 v72, s30, v104
  v_xor_b32 v73, s31, v105
  v_xor_b32 v74, s32, v106
  v_xor_b32 v75, s33, v107
  v_xor_b32 v76, s30, v108
  v_xor_b32 v77, s31, v109
  v_xor_b32 v78, s32, v110
  v_xor_b32 v79, s33, v111
  v_or3_b32 v28, v64, v65, v66
  v_or3_b32 v28, v28, v67, v68
  v_or3_b32 v28, v28, v69, v70
  v_or3_b32 v28, v28, v71, v72
  v_or3_b32 v28, v28, v73, v74
  v_or3_b32 v28, v28, v75, v76
  v_or3_b32 v28, v28, v77, v78
  v_or_b32 v28, v28, v79
  v_and_b32 v28, 15, v28
  v_cmp_ne_u32 vcc, 0, v28
  s_cbranch_vccz L_opk
  s_wqm_b64 exec, vcc
  buffer_load_dwordx4 v[96:99], v22, s[20:23], s34 offen offset:0 sc0 sc1
  buffer_load_dwordx4 v[100:103], v22, s[20:23], s34 offen offset:1024 sc0 sc1
  buffer_load_dwordx4 v[104:107], v22, s[20:23], s34 offen offset:2048 sc0 sc1
  buffer_load_dwordx4 v[108:111], v22, s[20:23], s34 offen offset:3072 sc0 sc1
  s_add_u32 s6, s6, 1
  s_cmp_lt_u32 s6, 0x2000
  s_cbranch_scc1 L_op
L_opk:
  s_mov_b64 exec, -1
  v_max_f32 v24, v66, v70
  v_max_f32 v25, v74, v78
  s_nop 0
  v_max_f32_dpp v24, v24, v24 row_ror:8 row_mask:0xf bank_mask:0xf
  v_max_f32_dpp v25, v25, v25 row_ror:8 row_mask:0xf bank_mask:0xf
  v_mov_b32 v26, v24
  v_mov_b32 v27, v25
  s_nop 0
  v_permlane16_swap_b32 v24, v26
  v_permlane16_swap_b32 v25, v27
  v_max_f32 v24, v24, v26
  v_max_f32 v25, v25, v27
  v_mov_b32 v26, v24
  v_mov_b32 v27, v25
  s_nop 0
  v_permlane32_swap_b32 v24, v26
  v_permlane32_swap_b32 v25, v27
  v_max_f32 v24, v24, v26
  v_max_f32 v25, v25, v27
  v_sub_f32 v66, v66, v24
  v_sub_f32 v70, v70, v24
  v_sub_f32 v74, v74, v25
  v_sub_f32 v78, v78, v25
  v_exp_f32 v66, v66
  v_exp_f32 v70, v70
  v_exp_f32 v74, v74
  v_exp_f32 v78, v78
  v_mul_f32 v64, v64, v66
  v_mul_f32 v65, v65, v66
  v_mul_f32 v67, v67, v66
  v_fma_f32 v64, v68, v70, v64
  v_fma_f32 v65, v69, v70, v65
  v_fma_f32 v67, v71, v70, v67
  v_mul_f32 v72, v72, v74
  v_mul_f32 v73, v73, v74
  v_mul_f32 v75, v75, v74
  v_fma_f32 v72, v76, v78, v72
  v_fma_f32 v73, v77, v78, v73
  v_fma_f32 v75, v79, v78, v75
  v_add_f32_dpp v64, v64, v64 row_ror:8 row_mask:0xf bank_mask:0x3
  v_add_f32_dpp v65, v65, v65 row_ror:8 row_mask:0xf bank_mask:0x3
  v_add_f32_dpp v67, v67, v67 row_ror:8 row_mask:0xf bank_mask:0x3
  v_add_f32_dpp v64, v72, v72 row_ror:8 row_mask:0xf bank_mask:0xc
  v_add_f32_dpp v65, v73, v73 row_ror:8 row_mask:0xf bank_mask:0xc
  v_add_f32_dpp v67, v75, v75 row_ror:8 row_mask:0xf bank_mask:0xc
  v_mov_b32 v26, v67
  v_permlane16_swap_b32 v64, v65
  s_nop 0
  v_permlane16_swap_b32 v67, v26
  v_add_f32 v64, v64, v65
  v_add_f32 v67, v67, v26
  v_mov_b32 v65, v64
  v_mov_b32 v26, v67
  s_nop 0
  v_permlane32_swap_b32 v64, v65
  v_permlane32_swap_b32 v67, v26
  v_add_f32 v64, v64, v65
  v_add_f32 v67, v67, v26
  v_rcp_f32 v67, v67
  s_nop 0
  v_mul_f32 v64, v64, v67
  v_cvt_pk_bf16_f32 v64, v64, v64
  s_nop 1
  v_mov_b32_dpp v24, v64 row_newbcast:0 row_mask:0x3 bank_mask:0x3
  v_mov_b32_dpp v25, v64 row_newbcast:1 row_mask:0x3 bank_mask:0x3
  v_mov_b32_dpp v26, v64 row_newbcast:2 row_mask:0x3 bank_mask:0x3
  v_mov_b32_dpp v27, v64 row_newbcast:3 row_mask:0x3 bank_mask:0x3
  v_mov_b32_dpp v24, v64 row_newbcast:8 row_mask:0x3 bank_mask:0xc
  v_mov_b32_dpp v25, v64 row_newbcast:9 row_mask:0x3 bank_mask:0xc
  v_mov_b32_dpp v26, v64 row_newbcast:10 row_mask:0x3 bank_mask:0xc
  v_mov_b32_dpp v27, v64 row_newbcast:11 row_mask:0x3 bank_mask:0xc
  v_mov_b32_dpp v24, v64 row_newbcast:4 row_mask:0xc bank_mask:0x3
  v_mov_b32_dpp v25, v64 row_newbcast:5 row_mask:0xc bank_mask:0x3
  v_mov_b32_dpp v26, v64 row_newbcast:6 row_mask:0xc bank_mask:0x3
  v_mov_b32_dpp v27, v64 row_newbcast:7 row_mask:0xc bank_mask:0x3
  v_mov_b32_dpp v24, v64 row_newbcast:12 row_mask:0xc bank_mask:0xc
  v_mov_b32_dpp v25, v64 row_newbcast:13 row_mask:0xc bank_mask:0xc
  v_mov_b32_dpp v26, v64 row_newbcast:14 row_mask:0xc bank_mask:0xc
  v_mov_b32_dpp v27, v64 row_newbcast:15 row_mask:0xc bank_mask:0xc
  v_and_b32 v32, v2, v24
  v_and_b32 v33, v3, v24
  v_and_b32 v34, v4, v24
  v_and_b32 v35, v5, v24
  v_and_b32 v36, v2, v25
  v_and_b32 v37, v3, v25
  v_and_b32 v38, v4, v25
  v_and_b32 v39, v5, v25
  v_and_b32 v40, v2, v26
  v_and_b32 v41, v3, v26
  v_and_b32 v42, v4, v26
  v_and_b32 v43, v5, v26
  v_and_b32 v44, v2, v27
  v_and_b32 v45, v3, v27
  v_and_b32 v46, v4, v27
  v_and_b32 v47, v5, v27
  v_mfma_f32_16x16x32_bf16 v[224:227], v[32:35], v[144:147], 0
  v_mfma_f32_16x16x32_bf16 v[224:227], v[36:39], v[164:167], v[224:227]
  v_mfma_f32_16x16x32_bf16 v[224:227], v[40:43], v[184:187], v[224:227]
  v_mfma_f32_16x16x32_bf16 v[224:227], v[44:47], v[204:207], v[224:227]
  v_mfma_f32_16x16x32_bf16 v[228:231], v[32:35], v[148:151], 0
  v_mfma_f32_16x16x32_bf16 v[228:231], v[36:39], v[168:171], v[228:231]
  v_mfma_f32_16x16x32_bf16 v[228:231], v[40:43], v[188:191], v[228:231]
  v_mfma_f32_16x16x32_bf16 v[228:231], v[44:47], v[208:211], v[228:231]
  s_nop 3
  v_and_or_b32 v224, v224, -16, s30
  v_and_or_b32 v225, v225, -16, s31
  v_and_or_b32 v226, v226, -16, s32
  v_and_or_b32 v227, v227, -16, s33
  buffer_store_dwordx4 v[224:227], v16, s[20:23], s63 offen sc0 sc1
  v_mfma_f32_16x16x32_bf16 v[232:235], v[32:35], v[152:155], 0
  v_mfma_f32_16x16x32_bf16 v[232:235], v[36:39], v[172:175], v[232:235]
  v_mfma_f32_16x16x32_bf16 v[232:235], v[40:43], v[192:195], v[232:235]
  v_mfma_f32_16x16x32_bf16 v[232:235], v[44:47], v[212:215], v[232:235]
  v_and_or_b32 v228, v228, -16, s30
  v_and_or_b32 v229, v229, -16, s31
  v_and_or_b32 v230, v230, -16, s32
  v_and_or_b32 v231, v231, -16, s33
  buffer_store_dwordx4 v[228:231], v16, s[20:23], s64 offen sc0 sc1
  v_mfma_f32_16x16x32_bf16 v[236:239], v[32:35], v[156:159], 0
  v_mfma_f32_16x16x32_bf16 v[236:239], v[36:39], v[176:179], v[236:239]
  v_mfma_f32_16x16x32_bf16 v[236:239], v[40:43], v[196:199], v[236:239]
  v_mfma_f32_16x16x32_bf16 v[236:239], v[44:47], v[216:219], v[236:239]
  v_and_or_b32 v232, v232, -16, s30
  v_and_or_b32 v233, v233, -16, s31
  v_and_or_b32 v234, v234, -16, s32
  v_and_or_b32 v235, v235, -16, s33
  buffer_store_dwordx4 v[232:235], v16, s[20:23], s65 offen sc0 sc1
  v_mfma_f32_16x16x32_bf16 v[240:243], v[32:35], v[160:163], 0
  v_mfma_f32_16x16x32_bf16 v[240:243], v[36:39], v[180:183], v[240:243]
  v_mfma_f32_16x16x32_bf16 v[240:243], v[40:43], v[200:203], v[240:243]
  v_mfma_f32_16x16x32_bf16 v[240:243], v[44:47], v[220:223], v[240:243]
  v_and_or_b32 v236, v236, -16, s30
  v_and_or_b32 v237, v237, -16, s31
  v_and_or_b32 v238, v238, -16, s32
  v_and_or_b32 v239, v239, -16, s33
  buffer_store_dwordx4 v[236:239], v16, s[20:23], s66 offen sc0 sc1
  s_nop 2
  v_and_or_b32 v240, v240, -16, s30
  v_and_or_b32 v241, v241, -16, s31
  v_and_or_b32 v242, v242, -16, s32
  v_and_or_b32 v243, v243, -16, s33
  buffer_store_dwordx4 v[240:243], v16, s[20:23], s67 offen sc0 sc1
  s_cmp_lt_i32 s27, 0
  s_cbranch_scc1 L_aend
  s_barrier
L_aend:
  s_endpgm
L_stream:
  s_sub_u32 s3, s3, 1
  s_xor_b32 s6, s3, s5
  s_and_b32 s6, s6, 1
  s_lshl_b32 s34, s6, 5
  s_add_u32 s34, s34, s4
  s_lshl_b32 s7, s34, 22
  v_and_b32 v6, 15, v0
  v_lshlrev_b32 v6, 4, v6
  v_bfe_u32 v7, v0, 4, 1
  v_lshl_add_u32 v6, v7, 13, v6
  v_lshrrev_b32 v7, 5, v0
  v_lshl_add_u32 v6, v7, 15, v6
  v_add_u32 v7, 65536, v6
  v_add_u32 v8, 131072, v6
  v_add_u32 v9, 196608, v6
  s_lshr_b32 s35, s3, 1
  s_lshl_b32 s24, s5, 1
  s_add_u32 s35, s35, s24
  s_and_b32 s67, s34, 15
  s_lshl_b32 s67, s67, 1
  s_bfe_u32 s64, s67, 0x10000
  s_lshl_b32 s64, s64, 18
  s_bfe_u32 s62, s67, 0x10001
  s_lshl_b32 s62, s62, 11
  s_or_b32 s64, s64, s62
  s_bfe_u32 s62, s67, 0x10002
  s_lshl_b32 s62, s62, 14
  s_or_b32 s64, s64, s62
  s_bfe_u32 s62, s67, 0x20003
  s_lshl_b32 s62, s62, 9
  s_or_b32 s64, s64, s62
  s_bfe_u32 s62, s67, 0x20005
  s_lshl_b32 s62, s62, 19
  s_or_b32 s64, s64, s62
  s_mov_b32 s63, s64
  s_mul_i32 s67, s35, 2
  s_mov_b32 s10, 0x400000
  s_mov_b32 s11, 0x20000
  s_mov_b32 s14, 0x400000
  s_mov_b32 s15, 0x20000
  s_waitcnt lgkmcnt(0)
  s_load_dword s70, s[58:59], 0
  s_add_u32 s8, s38, s7
  s_addc_u32 s9, s39, 0
  s_add_u32 s12, s40, s7
  s_addc_u32 s13, s41, 0
  s_mov_b64 s[40:41], s[8:9]
  s_mov_b64 s[42:43], s[10:11]
  s_mov_b64 s[44:45], s[12:13]
  s_mov_b64 s[46:47], s[14:15]
  s_mov_b64 s[48:49], s[8:9]
  s_mov_b64 s[50:51], s[12:13]
  s_add_u32 s12, s8, 262144
  s_addc_u32 s13, s9, 0
  s_mov_b64 s[44:45], s[12:13]
  s_bfe_u32 s24, s67, 0x10000
  s_lshl_b32 s24, s24, 18
  s_bfe_u32 s62, s67, 0x10001
  s_lshl_b32 s62, s62, 11
  s_or_b32 s24, s24, s62
  s_bfe_u32 s62, s67, 0x10002
  s_lshl_b32 s62, s62, 14
  s_or_b32 s24, s24, s62
  s_bfe_u32 s62, s67, 0x20003
  s_lshl_b32 s62, s62, 9
  s_or_b32 s24, s24, s62
  s_bfe_u32 s62, s67, 0x30005
  s_lshl_b32 s62, s62, 19
  s_or_b32 s24, s24, s62
  s_xor_b32 s24, s24, s64
  s_xor_b32 s66, s24, 4096
  s_barrier
  buffer_load_dwordx4 v[64:67], v6, s[8:11], s24 offen offset:0 nt
  buffer_load_dwordx4 v[68:71], v6, s[8:11], s24 offen offset:256 nt
  buffer_load_dwordx4 v[72:75], v6, s[8:11], s66 offen offset:0 nt
  buffer_load_dwordx4 v[76:79], v6, s[8:11], s66 offen offset:256 nt
  buffer_load_dwordx4 v[80:83], v7, s[8:11], s24 offen offset:0 nt
  buffer_load_dwordx4 v[84:87], v7, s[8:11], s24 offen offset:256 nt
  buffer_load_dwordx4 v[88:91], v7, s[8:11], s66 offen offset:0 nt
  buffer_load_dwordx4 v[92:95], v7, s[8:11], s66 offen offset:256 nt
  buffer_load_dwordx4 v[96:99], v8, s[40:43], s24 offen offset:0 nt
  buffer_load_dwordx4 v[100:103], v8, s[40:43], s24 offen offset:256 nt
  buffer_load_dwordx4 v[104:107], v8, s[40:43], s66 offen offset:0 nt
  buffer_load_dwordx4 v[108:111], v8, s[40:43], s66 offen offset:256 nt
  buffer_load_dwordx4 v[112:115], v9, s[40:43], s24 offen offset:0 nt
  buffer_load_dwordx4 v[116:119], v9, s[40:43], s24 offen offset:256 nt
  buffer_load_dwordx4 v[120:123], v9, s[40:43], s66 offen offset:0 nt
  buffer_load_dwordx4 v[124:127], v9, s[40:43], s66 offen offset:256 nt
  s_nop 0
  buffer_load_dwordx4 v[128:131], v6, s[12:15], s24 offen offset:0 nt
  buffer_load_dwordx4 v[132:135], v6, s[12:15], s24 offen offset:256 nt
  buffer_load_dwordx4 v[136:139], v6, s[12:15], s66 offen offset:0 nt
  buffer_load_dwordx4 v[140:143], v6, s[12:15], s66 offen offset:256 nt
  buffer_load_dwordx4 v[144:147], v7, s[12:15], s24 offen offset:0 nt
  buffer_load_dwordx4 v[148:151], v7, s[12:15], s24 offen offset:256 nt
  buffer_load_dwordx4 v[152:155], v7, s[12:15], s66 offen offset:0 nt
  buffer_load_dwordx4 v[156:159], v7, s[12:15], s66 offen offset:256 nt
  buffer_load_dwordx4 v[160:163], v8, s[44:47], s24 offen offset:0 nt
  buffer_load_dwordx4 v[164:167], v8, s[44:47], s24 offen offset:256 nt
  buffer_load_dwordx4 v[168:171], v8, s[44:47], s66 offen offset:0 nt
  buffer_load_dwordx4 v[172:175], v8, s[44:47], s66 offen offset:256 nt
  buffer_load_dwordx4 v[176:179], v9, s[44:47], s24 offen offset:0 nt
  buffer_load_dwordx4 v[180:183], v9, s[44:47], s24 offen offset:256 nt
  buffer_load_dwordx4 v[184:187], v9, s[44:47], s66 offen offset:0 nt
  buffer_load_dwordx4 v[188:191], v9, s[44:47], s66 offen offset:256 nt
  s_add_u32 s67, s67, 32
  s_bfe_u32 s24, s67, 0x10000
  s_lshl_b32 s24, s24, 18
  s_bfe_u32 s62, s67, 0x10001
  s_lshl_b32 s62, s62, 11
  s_or_b32 s24, s24, s62
  s_bfe_u32 s62, s67, 0x10002
  s_lshl_b32 s62, s62, 14
  s_or_b32 s24, s24, s62
  s_bfe_u32 s62, s67, 0x20003
  s_lshl_b32 s62, s62, 9
  s_or_b32 s24, s24, s62
  s_bfe_u32 s62, s67, 0x30005
  s_lshl_b32 s62, s62, 19
  s_or_b32 s24, s24, s62
  s_xor_b32 s24, s24, s64
  s_xor_b32 s66, s24, 4096
  s_nop 0
  buffer_load_dwordx4 v[192:195], v6, s[8:11], s24 offen offset:0 nt
  buffer_load_dwordx4 v[196:199], v6, s[8:11], s24 offen offset:256 nt
  buffer_load_dwordx4 v[200:203], v6, s[8:11], s66 offen offset:0 nt
  buffer_load_dwordx4 v[204:207], v6, s[8:11], s66 offen offset:256 nt
  buffer_load_dwordx4 v[208:211], v7, s[8:11], s24 offen offset:0 nt
  buffer_load_dwordx4 v[212:215], v7, s[8:11], s24 offen offset:256 nt
  buffer_load_dwordx4 v[216:219], v7, s[8:11], s66 offen offset:0 nt
  buffer_load_dwordx4 v[220:223], v7, s[8:11], s66 offen offset:256 nt
  buffer_load_dwordx4 v[224:227], v8, s[40:43], s24 offen offset:0 nt
  buffer_load_dwordx4 v[228:231], v8, s[40:43], s24 offen offset:256 nt
  buffer_load_dwordx4 v[232:235], v8, s[40:43], s66 offen offset:0 nt
  buffer_load_dwordx4 v[236:239], v8, s[40:43], s66 offen offset:256 nt
  buffer_load_dwordx4 v[240:243], v9, s[40:43], s24 offen offset:0 nt
  buffer_load_dwordx4 v[244:247], v9, s[40:43], s24 offen offset:256 nt
  buffer_load_dwordx4 v[248:251], v9, s[40:43], s66 offen offset:0 nt
  buffer_load_dwordx4 v[252:255], v9, s[40:43], s66 offen offset:256 nt
  s_sub_u32 s67, s67, 32
  s_mov_b32 s28, 0x3db504f3
  s_mov_b32 s29, 0x3fb8aa3b
  s_mov_b32 s20, s58
  s_mov_b32 s21, s59
  s_mov_b32 s22, 5668864
  s_mov_b32 s23, 0x20000
  v_and_b32 v19, 1, v0
  v_cmp_eq_u32 vcc, 1, v19
  v_mov_b32 v20, 0xffff
  v_mov_b32 v21, s26
  v_cndmask_b32 v20, v20, v21, vcc
  v_bfe_u32 v19, v0, 1, 3
  v_cmp_eq_u32 vcc, 0, v19
  s_nop 1
  v_cndmask_b32 v2, 0, v20, vcc
  v_cmp_eq_u32 vcc, 1, v19
  s_nop 1
  v_cndmask_b32 v3, 0, v20, vcc
  v_cmp_eq_u32 vcc, 2, v19
  s_nop 1
  v_cndmask_b32 v4, 0, v20, vcc
  v_cmp_eq_u32 vcc, 3, v19
  s_nop 1
  v_cndmask_b32 v5, 0, v20, vcc
  v_mov_b32 v14, 0
  v_mov_b32 v15, 0
  v_mov_b32 v16, 0
  v_mov_b32 v17, 0
  v_mov_b32 v18, 0xff800000
  v_mov_b32 v19, 0
  s_lshl_b32 s7, s34, 8
  s_add_u32 s7, s7, 4096
  v_mov_b32 v20, s7
  v_mov_b32 v21, 1
  v_lshl_add_u32 v20, v0, 24, v20
  v_and_b32 v1, 15, v0
  v_lshlrev_b32 v1, 4, v1
  s_lshl_b32 s7, s6, 8
  s_add_u32 s7, s7, 5120
  v_add_u32 v1, s7, v1
  v_bfe_u32 v56, v0, 2, 2
  v_lshlrev_b32 v56, 13, v56
  v_and_b32 v57, 3, v0
  v_lshl_add_u32 v56, v57, 4, v56
  v_bfe_u32 v57, v0, 4, 1
  v_lshl_add_u32 v56, v57, 12, v56
  v_lshrrev_b32 v57, 5, v0
  v_lshl_add_u32 v56, v57, 6, v56
  s_lshl_b32 s65, s4, 15
  s_lshl_b32 s6, s6, 4
  s_add_u32 s6, s6, s35
  s_lshl_b32 s6, s6, 7
  s_add_u32 s65, s65, s6
  s_add_u32 s65, s65, 786432
  s_mov_b32 s25, 0
  s_mov_b32 s61, 0
  s_waitcnt lgkmcnt(0)
  s_add_u32 s30, s70, 1
  s_and_b32 s30, s30, 15
  s_xor_b32 s31, s30, 15
  s_lshr_b32 s32, s70, 4
  s_add_u32 s32, s32, 1
  s_and_b32 s32, s32, 15
  s_lshr_b32 s33, s70, 8
  s_add_u32 s33, s33, 1
  s_and_b32 s33, s33, 15
  s_mov_b32 s7, 0
  v_mov_b32 v23, 0
L_qw:
  ds_read_b32 v24, v23 offset:5632
  ds_read_b128 v[10:13], v1
  s_add_u32 s7, s7, 1
  s_waitcnt lgkmcnt(0)
  v_cmp_ne_u32 vcc, 0, v24
  s_cbranch_vccnz L_qgo
  s_sleep 1
  s_cmp_lt_u32 s7, 0x40000
  s_cbranch_scc1 L_qw
L_qgo:
  v_lshrrev_b32 v57, 2, v0
  v_lshlrev_b32 v57, 4, v57
  s_lshl_b32 s7, s3, 14
  s_add_u32 s7, s7, 0x8000
  v_add_u32 v57, s7, v57
  v_mov_b32 v59, v57
  s_mov_b32 s52, 0
L_kloop:
  s_cmp_lg_u32 s25, 1
  s_cbranch_scc1 L_nocopy
  s_waitcnt vmcnt(16)
  v_mov_b32 v64, v192
  v_mov_b32 v65, v193
  v_mov_b32 v66, v194
  v_mov_b32 v67, v195
  v_mov_b32 v68, v196
  v_mov_b32 v69, v197
  v_mov_b32 v70, v198
  v_mov_b32 v71, v199
  v_mov_b32 v72, v200
  v_mov_b32 v73, v201
  v_mov_b32 v74, v202
  v_mov_b32 v75, v203
  v_mov_b32 v76, v204
  v_mov_b32 v77, v205
  v_mov_b32 v78, v206
  v_mov_b32 v79, v207
  v_mov_b32 v80, v208
  v_mov_b32 v81, v209
  v_mov_b32 v82, v210
  v_mov_b32 v83, v211
  v_mov_b32 v84, v212
  v_mov_b32 v85, v213
  v_mov_b32 v86, v214
  v_mov_b32 v87, v215
  v_mov_b32 v88, v216
  v_mov_b32 v89, v217
  v_mov_b32 v90, v218
  v_mov_b32 v91, v219
  v_mov_b32 v92, v220
  v_mov_b32 v93, v221
  v_mov_b32 v94, v222
  v_mov_b32 v95, v223
  v_mov_b32 v96, v224
  v_mov_b32 v97, v225
  v_mov_b32 v98, v226
  v_mov_b32 v99, v227
  v_mov_b32 v100, v228
  v_mov_b32 v101, v229
  v_mov_b32 v102, v230
  v_mov_b32 v103, v231
  v_mov_b32 v104, v232
  v_mov_b32 v105, v233
  v_mov_b32 v106, v234
  v_mov_b32 v107, v235
  v_mov_b32 v108, v236
  v_mov_b32 v109, v237
  v_mov_b32 v110, v238
  v_mov_b32 v111, v239
  v_mov_b32 v112, v240
  v_mov_b32 v113, v241
  v_mov_b32 v114, v242
  v_mov_b32 v115, v243
  v_mov_b32 v116, v244
  v_mov_b32 v117, v245
  v_mov_b32 v118, v246
  v_mov_b32 v119, v247
  v_mov_b32 v120, v248
  v_mov_b32 v121, v249
  v_mov_b32 v122, v250
  v_mov_b32 v123, v251
  v_mov_b32 v124, v252
  v_mov_b32 v125, v253
  v_mov_b32 v126, v254
  v_mov_b32 v127, v255
L_nocopy:
  s_waitcnt vmcnt(31)
  v_dot2_f32_bf16 v24, v64, v10, 0
  v_dot2_f32_bf16 v24, v65, v11, v24
  v_dot2_f32_bf16 v24, v66, v12, v24
  v_dot2_f32_bf16 v24, v67, v13, v24
  s_waitcnt vmcnt(30)
  v_dot2_f32_bf16 v25, v68, v10, 0
  v_dot2_f32_bf16 v25, v69, v11, v25
  v_dot2_f32_bf16 v25, v70, v12, v25
  v_dot2_f32_bf16 v25, v71, v13, v25
  s_waitcnt vmcnt(29)
  v_dot2_f32_bf16 v26, v72, v10, 0
  v_dot2_f32_bf16 v26, v73, v11, v26
  v_dot2_f32_bf16 v26, v74, v12, v26
  v_dot2_f32_bf16 v26, v75, v13, v26
  s_waitcnt vmcnt(28)
  v_dot2_f32_bf16 v27, v76, v10, 0
  v_dot2_f32_bf16 v27, v77, v11, v27
  v_dot2_f32_bf16 v27, v78, v12, v27
  v_dot2_f32_bf16 v27, v79, v13, v27
  s_waitcnt vmcnt(27)
  v_dot2_f32_bf16 v28, v80, v10, 0
  v_dot2_f32_bf16 v28, v81, v11, v28
  v_dot2_f32_bf16 v28, v82, v12, v28
  v_dot2_f32_bf16 v28, v83, v13, v28
  v_add_f32_dpp v24, v24, v24 row_ror:8 row_mask:0xf bank_mask:0x3
  v_add_f32_dpp v26, v26, v26 row_ror:8 row_mask:0xf bank_mask:0x3
  s_nop 0
  v_add_f32_dpp v24, v25, v25 row_ror:8 row_mask:0xf bank_mask:0xc
  v_add_f32_dpp v26, v27, v27 row_ror:8 row_mask:0xf bank_mask:0xc
  s_waitcnt vmcnt(26)
  v_dot2_f32_bf16 v29, v84, v10, 0
  v_dot2_f32_bf16 v29, v85, v11, v29
  v_dot2_f32_bf16 v29, v86, v12, v29
  v_dot2_f32_bf16 v29, v87, v13, v29
  v_add_f32_dpp v40, v24, v24 row_shl:4 row_mask:0xf bank_mask:0x5
  s_nop 1
  v_add_f32_dpp v40, v26, v26 row_shr:4 row_mask:0xf bank_mask:0xa
  s_waitcnt vmcnt(25)
  v_dot2_f32_bf16 v30, v88, v10, 0
  v_dot2_f32_bf16 v30, v89, v11, v30
  v_dot2_f32_bf16 v30, v90, v12, v30
  v_dot2_f32_bf16 v30, v91, v13, v30
  s_waitcnt vmcnt(24)
  v_dot2_f32_bf16 v31, v92, v10, 0
  v_dot2_f32_bf16 v31, v93, v11, v31
  v_dot2_f32_bf16 v31, v94, v12, v31
  v_dot2_f32_bf16 v31, v95, v13, v31
  s_waitcnt vmcnt(23)
  v_dot2_f32_bf16 v32, v96, v10, 0
  v_dot2_f32_bf16 v32, v97, v11, v32
  v_dot2_f32_bf16 v32, v98, v12, v32
  v_dot2_f32_bf16 v32, v99, v13, v32
  v_add_f32_dpp v28, v28, v28 row_ror:8 row_mask:0xf bank_mask:0x3
  v_add_f32_dpp v30, v30, v30 row_ror:8 row_mask:0xf bank_mask:0x3
  s_nop 0
  v_add_f32_dpp v28, v29, v29 row_ror:8 row_mask:0xf bank_mask:0xc
  v_add_f32_dpp v30, v31, v31 row_ror:8 row_mask:0xf bank_mask:0xc
  s_waitcnt vmcnt(22)
  v_dot2_f32_bf16 v33, v100, v10, 0
  v_dot2_f32_bf16 v33, v101, v11, v33
  v_dot2_f32_bf16 v33, v102, v12, v33
  v_dot2_f32_bf16 v33, v103, v13, v33
  v_add_f32_dpp v41, v28, v28 row_shl:4 row_mask:0xf bank_mask:0x5
  s_nop 1
  v_add_f32_dpp v41, v30, v30 row_shr:4 row_mask:0xf bank_mask:0xa
  s_waitcnt vmcnt(21)
  v_dot2_f32_bf16 v34, v104, v10, 0
  v_dot2_f32_bf16 v34, v105, v11, v34
  v_dot2_f32_bf16 v34, v106, v12, v34
  v_dot2_f32_bf16 v34, v107, v13, v34
  s_waitcnt vmcnt(20)
  v_dot2_f32_bf16 v35, v108, v10, 0
  v_dot2_f32_bf16 v35, v109, v11, v35
  v_dot2_f32_bf16 v35, v110, v12, v35
  v_dot2_f32_bf16 v35, v111, v13, v35
  s_waitcnt vmcnt(19)
  v_dot2_f32_bf16 v36, v112, v10, 0
  v_dot2_f32_bf16 v36, v113, v11, v36
  v_dot2_f32_bf16 v36, v114, v12, v36
  v_dot2_f32_bf16 v36, v115, v13, v36
  v_add_f32_dpp v32, v32, v32 row_ror:8 row_mask:0xf bank_mask:0x3
  v_add_f32_dpp v34, v34, v34 row_ror:8 row_mask:0xf bank_mask:0x3
  s_nop 0
  v_add_f32_dpp v32, v33, v33 row_ror:8 row_mask:0xf bank_mask:0xc
  v_add_f32_dpp v34, v35, v35 row_ror:8 row_mask:0xf bank_mask:0xc
  s_waitcnt vmcnt(18)
  v_dot2_f32_bf16 v37, v116, v10, 0
  v_dot2_f32_bf16 v37, v117, v11, v37
  v_dot2_f32_bf16 v37, v118, v12, v37
  v_dot2_f32_bf16 v37, v119, v13, v37
  v_add_f32_dpp v42, v32, v32 row_shl:4 row_mask:0xf bank_mask:0x5
  s_nop 1
  v_add_f32_dpp v42, v34, v34 row_shr:4 row_mask:0xf bank_mask:0xa
  s_waitcnt vmcnt(17)
  v_dot2_f32_bf16 v38, v120, v10, 0
  v_dot2_f32_bf16 v38, v121, v11, v38
  v_dot2_f32_bf16 v38, v122, v12, v38
  v_dot2_f32_bf16 v38, v123, v13, v38
  s_waitcnt vmcnt(16)
  v_dot2_f32_bf16 v39, v124, v10, 0
  v_dot2_f32_bf16 v39, v125, v11, v39
  v_dot2_f32_bf16 v39, v126, v12, v39
  v_dot2_f32_bf16 v39, v127, v13, v39
  s_mov_b32 m0, s25
  v_readfirstlane_b32 s7, v22
  v_writelane_b32 v58, s67, m0
  s_lshl_b32 s69, s67, 8
  s_add_u32 s67, s67, 32
  s_add_u32 s25, s25, 1
  s_cmp_lt_u32 s25, 5
  s_cbranch_scc1 L_kst
  s_lshl_b32 s67, s7, 1
  s_add_u32 s67, s67, 160
  s_cmp_lt_u32 s7, 36
  s_cbranch_scc1 L_kst
  v_readlane_b32 s67, v58, 0
  s_mov_b64 s[8:9], s[50:51]
  s_mov_b64 s[40:41], s[50:51]
  s_mov_b32 s52, 1
  s_nop 3
L_kst:
  s_bfe_u32 s24, s67, 0x10000
  s_lshl_b32 s24, s24, 18
  s_bfe_u32 s62, s67, 0x10001
  s_lshl_b32 s62, s62, 11
  s_or_b32 s24, s24, s62
  s_bfe_u32 s62, s67, 0x10002
  s_lshl_b32 s62, s62, 14
  s_or_b32 s24, s24, s62
  s_bfe_u32 s62, s67, 0x20003
  s_lshl_b32 s62, s62, 9
  s_or_b32 s24, s24, s62
  s_bfe_u32 s62, s67, 0x30005
  s_lshl_b32 s62, s62, 19
  s_or_b32 s24, s24, s62
  s_xor_b32 s24, s24, s64
  s_xor_b32 s66, s24, 4096
  s_cmp_eq_u32 s25, 1
  s_cbranch_scc1 L_nok
  buffer_load_dwordx4 v[64:67], v6, s[8:11], s24 offen offset:0 nt
  buffer_load_dwordx4 v[68:71], v6, s[8:11], s24 offen offset:256 nt
  buffer_load_dwordx4 v[72:75], v6, s[8:11], s66 offen offset:0 nt
  buffer_load_dwordx4 v[76:79], v6, s[8:11], s66 offen offset:256 nt
  buffer_load_dwordx4 v[80:83], v7, s[8:11], s24 offen offset:0 nt
  buffer_load_dwordx4 v[84:87], v7, s[8:11], s24 offen offset:256 nt
  buffer_load_dwordx4 v[88:91], v7, s[8:11], s66 offen offset:0 nt
  buffer_load_dwordx4 v[92:95], v7, s[8:11], s66 offen offset:256 nt
  buffer_load_dwordx4 v[96:99], v8, s[40:43], s24 offen offset:0 nt
  buffer_load_dwordx4 v[100:103], v8, s[40:43], s24 offen offset:256 nt
  buffer_load_dwordx4 v[104:107], v8, s[40:43], s66 offen offset:0 nt
  buffer_load_dwordx4 v[108:111], v8, s[40:43], s66 offen offset:256 nt
  buffer_load_dwordx4 v[112:115], v9, s[40:43], s24 offen offset:0 nt
  buffer_load_dwordx4 v[116:119], v9, s[40:43], s24 offen offset:256 nt
  buffer_load_dwordx4 v[120:123], v9, s[40:43], s66 offen offset:0 nt
  buffer_load_dwordx4 v[124:127], v9, s[40:43], s66 offen offset:256 nt
L_nok:
  v_add_f32_dpp v36, v36, v36 row_ror:8 row_mask:0xf bank_mask:0x3
  v_add_f32_dpp v38, v38, v38 row_ror:8 row_mask:0xf bank_mask:0x3
  s_nop 0
  v_add_f32_dpp v36, v37, v37 row_ror:8 row_mask:0xf bank_mask:0xc
  v_add_f32_dpp v38, v39, v39 row_ror:8 row_mask:0xf bank_mask:0xc
  s_nop 0
  v_add_f32_dpp v43, v36, v36 row_shl:4 row_mask:0xf bank_mask:0x5
  s_nop 1
  v_add_f32_dpp v43, v38, v38 row_shr:4 row_mask:0xf bank_mask:0xa
  v_add_f32_dpp v40, v40, v40 quad_perm:[1,0,3,2] row_mask:0xf bank_mask:0xf
  v_add_f32_dpp v41, v41, v41 quad_perm:[1,0,3,2] row_mask:0xf bank_mask:0xf
  v_add_f32_dpp v42, v42, v42 quad_perm:[1,0,3,2] row_mask:0xf bank_mask:0xf
  v_add_f32_dpp v43, v43, v43 quad_perm:[1,0,3,2] row_mask:0xf bank_mask:0xf
  v_add_f32_dpp v40, v40, v40 quad_perm:[2,3,0,1] row_mask:0xf bank_mask:0xf
  v_add_f32_dpp v41, v41, v41 quad_perm:[2,3,0,1] row_mask:0xf bank_mask:0xf
  v_add_f32_dpp v42, v42, v42 quad_perm:[2,3,0,1] row_mask:0xf bank_mask:0xf
  v_add_f32_dpp v43, v43, v43 quad_perm:[2,3,0,1] row_mask:0xf bank_mask:0xf
  v_cvt_pk_bf16_f32 v44, v40, v41
  v_cvt_pk_bf16_f32 v45, v42, v43
  v_lshlrev_b32 v40, 16, v44
  v_and_b32 v41, s26, v44
  v_lshlrev_b32 v42, 16, v45
  v_and_b32 v43, s26, v45
  v_mul_f32 v40, s28, v40
  v_mul_f32 v41, s28, v41
  v_mul_f32 v42, s28, v42
  v_mul_f32 v43, s28, v43
  v_cvt_pk_bf16_f32 v60, v40, v41
  v_cvt_pk_bf16_f32 v61, v42, v43
  s_waitcnt vmcnt(31)
  v_dot2_f32_bf16 v24, v128, v10, 0
  v_dot2_f32_bf16 v24, v129, v11, v24
  v_dot2_f32_bf16 v24, v130, v12, v24
  v_dot2_f32_bf16 v24, v131, v13, v24
  s_waitcnt vmcnt(30)
  v_dot2_f32_bf16 v25, v132, v10, 0
  v_dot2_f32_bf16 v25, v133, v11, v25
  v_dot2_f32_bf16 v25, v134, v12, v25
  v_dot2_f32_bf16 v25, v135, v13, v25
  s_waitcnt vmcnt(29)
  v_dot2_f32_bf16 v26, v136, v10, 0
  v_dot2_f32_bf16 v26, v137, v11, v26
  v_dot2_f32_bf16 v26, v138, v12, v26
  v_dot2_f32_bf16 v26, v139, v13, v26
  s_waitcnt vmcnt(28)
  v_dot2_f32_bf16 v27, v140, v10, 0
  v_dot2_f32_bf16 v27, v141, v11, v27
  v_dot2_f32_bf16 v27, v142, v12, v27
  v_dot2_f32_bf16 v27, v143, v13, v27
  s_waitcnt vmcnt(27)
  v_dot2_f32_bf16 v28, v144, v10, 0
  v_dot2_f32_bf16 v28, v145, v11, v28
  v_dot2_f32_bf16 v28, v146, v12, v28
  v_dot2_f32_bf16 v28, v147, v13, v28
  v_add_f32_dpp v24, v24, v24 row_ror:8 row_mask:0xf bank_mask:0x3
  v_add_f32_dpp v26, v26, v26 row_ror:8 row_mask:0xf bank_mask:0x3
  s_nop 0
  v_add_f32_dpp v24, v25, v25 row_ror:8 row_mask:0xf bank_mask:0xc
  v_add_f32_dpp v26, v27, v27 row_ror:8 row_mask:0xf bank_mask:0xc
  s_waitcnt vmcnt(26)
  v_dot2_f32_bf16 v29, v148, v10, 0
  v_dot2_f32_bf16 v29, v149, v11, v29
  v_dot2_f32_bf16 v29, v150, v12, v29
  v_dot2_f32_bf16 v29, v151, v13, v29
  v_add_f32_dpp v40, v24, v24 row_shl:4 row_mask:0xf bank_mask:0x5
  s_nop 1
  v_add_f32_dpp v40, v26, v26 row_shr:4 row_mask:0xf bank_mask:0xa
  s_waitcnt vmcnt(25)
  v_dot2_f32_bf16 v30, v152, v10, 0
  v_dot2_f32_bf16 v30, v153, v11, v30
  v_dot2_f32_bf16 v30, v154, v12, v30
  v_dot2_f32_bf16 v30, v155, v13, v30
  s_waitcnt vmcnt(24)
  v_dot2_f32_bf16 v31, v156, v10, 0
  v_dot2_f32_bf16 v31, v157, v11, v31
  v_dot2_f32_bf16 v31, v158, v12, v31
  v_dot2_f32_bf16 v31, v159, v13, v31
  s_waitcnt vmcnt(23)
  v_dot2_f32_bf16 v32, v160, v10, 0
  v_dot2_f32_bf16 v32, v161, v11, v32
  v_dot2_f32_bf16 v32, v162, v12, v32
  v_dot2_f32_bf16 v32, v163, v13, v32
  v_add_f32_dpp v28, v28, v28 row_ror:8 row_mask:0xf bank_mask:0x3
  v_add_f32_dpp v30, v30, v30 row_ror:8 row_mask:0xf bank_mask:0x3
  s_nop 0
  v_add_f32_dpp v28, v29, v29 row_ror:8 row_mask:0xf bank_mask:0xc
  v_add_f32_dpp v30, v31, v31 row_ror:8 row_mask:0xf bank_mask:0xc
  s_waitcnt vmcnt(22)
  v_dot2_f32_bf16 v33, v164, v10, 0
  v_dot2_f32_bf16 v33, v165, v11, v33
  v_dot2_f32_bf16 v33, v166, v12, v33
  v_dot2_f32_bf16 v33, v167, v13, v33
  v_add_f32_dpp v41, v28, v28 row_shl:4 row_mask:0xf bank_mask:0x5
  s_nop 1
  v_add_f32_dpp v41, v30, v30 row_shr:4 row_mask:0xf bank_mask:0xa
  s_waitcnt vmcnt(21)
  v_dot2_f32_bf16 v34, v168, v10, 0
  v_dot2_f32_bf16 v34, v169, v11, v34
  v_dot2_f32_bf16 v34, v170, v12, v34
  v_dot2_f32_bf16 v34, v171, v13, v34
  s_waitcnt vmcnt(20)
  v_dot2_f32_bf16 v35, v172, v10, 0
  v_dot2_f32_bf16 v35, v173, v11, v35
  v_dot2_f32_bf16 v35, v174, v12, v35
  v_dot2_f32_bf16 v35, v175, v13, v35
  s_waitcnt vmcnt(19)
  v_dot2_f32_bf16 v36, v176, v10, 0
  v_dot2_f32_bf16 v36, v177, v11, v36
  v_dot2_f32_bf16 v36, v178, v12, v36
  v_dot2_f32_bf16 v36, v179, v13, v36
  v_add_f32_dpp v32, v32, v32 row_ror:8 row_mask:0xf bank_mask:0x3
  v_add_f32_dpp v34, v34, v34 row_ror:8 row_mask:0xf bank_mask:0x3
  s_nop 0
  v_add_f32_dpp v32, v33, v33 row_ror:8 row_mask:0xf bank_mask:0xc
  v_add_f32_dpp v34, v35, v35 row_ror:8 row_mask:0xf bank_mask:0xc
  s_waitcnt vmcnt(18)
  v_dot2_f32_bf16 v37, v180, v10, 0
  v_dot2_f32_bf16 v37, v181, v11, v37
  v_dot2_f32_bf16 v37, v182, v12, v37
  v_dot2_f32_bf16 v37, v183, v13, v37
  v_add_f32_dpp v42, v32, v32 row_shl:4 row_mask:0xf bank_mask:0x5
  s_nop 1
  v_add_f32_dpp v42, v34, v34 row_shr:4 row_mask:0xf bank_mask:0xa
  s_waitcnt vmcnt(17)
  v_dot2_f32_bf16 v38, v184, v10, 0
  v_dot2_f32_bf16 v38, v185, v11, v38
  v_dot2_f32_bf16 v38, v186, v12, v38
  v_dot2_f32_bf16 v38, v187, v13, v38
  s_waitcnt vmcnt(16)
  v_dot2_f32_bf16 v39, v188, v10, 0
  v_dot2_f32_bf16 v39, v189, v11, v39
  v_dot2_f32_bf16 v39, v190, v12, v39
  v_dot2_f32_bf16 v39, v191, v13, v39
  s_add_u32 s12, s8, 262144
  s_addc_u32 s13, s9, 0
  s_mov_b64 s[44:45], s[12:13]
  v_mov_b32 v22, 1
  s_cmp_lt_u32 s25, 4
  s_cbranch_scc1 L_knoat
  s_cmp_lg_u32 s52, 0
  s_cbranch_scc1 L_knoat
  buffer_atomic_add v22, v20, s[20:23], 0 offen sc0 sc1
L_knoat:
  buffer_load_dwordx4 v[128:131], v6, s[12:15], s24 offen offset:0 nt
  buffer_load_dwordx4 v[132:135], v6, s[12:15], s24 offen offset:256 nt
  buffer_load_dwordx4 v[136:139], v6, s[12:15], s66 offen offset:0 nt
  buffer_load_dwordx4 v[140:143], v6, s[12:15], s66 offen offset:256 nt
  buffer_load_dwordx4 v[144:147], v7, s[12:15], s24 offen offset:0 nt
  buffer_load_dwordx4 v[148:151], v7, s[12:15], s24 offen offset:256 nt
  buffer_load_dwordx4 v[152:155], v7, s[12:15], s66 offen offset:0 nt
  buffer_load_dwordx4 v[156:159], v7, s[12:15], s66 offen offset:256 nt
  buffer_load_dwordx4 v[160:163], v8, s[44:47], s24 offen offset:0 nt
  buffer_load_dwordx4 v[164:167], v8, s[44:47], s24 offen offset:256 nt
  buffer_load_dwordx4 v[168:171], v8, s[44:47], s66 offen offset:0 nt
  buffer_load_dwordx4 v[172:175], v8, s[44:47], s66 offen offset:256 nt
  buffer_load_dwordx4 v[176:179], v9, s[44:47], s24 offen offset:0 nt
  buffer_load_dwordx4 v[180:183], v9, s[44:47], s24 offen offset:256 nt
  buffer_load_dwordx4 v[184:187], v9, s[44:47], s66 offen offset:0 nt
  buffer_load_dwordx4 v[188:191], v9, s[44:47], s66 offen offset:256 nt
  v_add_f32_dpp v36, v36, v36 row_ror:8 row_mask:0xf bank_mask:0x3
  v_add_f32_dpp v38, v38, v38 row_ror:8 row_mask:0xf bank_mask:0x3
  s_nop 0
  v_add_f32_dpp v36, v37, v37 row_ror:8 row_mask:0xf bank_mask:0xc
  v_add_f32_dpp v38, v39, v39 row_ror:8 row_mask:0xf bank_mask:0xc
  s_nop 0
  v_add_f32_dpp v43, v36, v36 row_shl:4 row_mask:0xf bank_mask:0x5
  s_nop 1
  v_add_f32_dpp v43, v38, v38 row_shr:4 row_mask:0xf bank_mask:0xa
  v_add_f32_dpp v40, v40, v40 quad_perm:[1,0,3,2] row_mask:0xf bank_mask:0xf
  v_add_f32_dpp v41, v41, v41 quad_perm:[1,0,3,2] row_mask:0xf bank_mask:0xf
  v_add_f32_dpp v42, v42, v42 quad_perm:[1,0,3,2] row_mask:0xf bank_mask:0xf
  v_add_f32_dpp v43, v43, v43 quad_perm:[1,0,3,2] row_mask:0xf bank_mask:0xf
  v_add_f32_dpp v40, v40, v40 quad_perm:[2,3,0,1] row_mask:0xf bank_mask:0xf
  v_add_f32_dpp v41, v41, v41 quad_perm:[2,3,0,1] row_mask:0xf bank_mask:0xf
  v_add_f32_dpp v42, v42, v42 quad_perm:[2,3,0,1] row_mask:0xf bank_mask:0xf
  v_add_f32_dpp v43, v43, v43 quad_perm:[2,3,0,1] row_mask:0xf bank_mask:0xf
  v_cvt_pk_bf16_f32 v44, v40, v41
  v_cvt_pk_bf16_f32 v45, v42, v43
  v_lshlrev_b32 v40, 16, v44
  v_and_b32 v41, s26, v44
  v_lshlrev_b32 v42, 16, v45
  v_and_b32 v43, s26, v45
  v_mul_f32 v40, s28, v40
  v_mul_f32 v41, s28, v41
  v_mul_f32 v42, s28, v42
  v_mul_f32 v43, s28, v43
  v_cvt_pk_bf16_f32 v62, v40, v41
  v_cvt_pk_bf16_f32 v63, v42, v43
  ds_write_b128 v59, v[60:63]
  v_add_u32 v59, 0x100, v59
  s_cmp_eq_u32 s52, 0
  s_cbranch_scc1 L_kloop
  s_mov_b32 s53, s25
  s_sub_u32 s52, s25, 1
  s_mov_b32 s25, 0
L_vloop:
  ds_read_b128 v[60:63], v57
  v_add_u32 v57, 0x100, v57
  s_add_u32 s25, s25, 1
  v_readlane_b32 s67, v58, s25
  s_waitcnt lgkmcnt(0)
  v_lshlrev_b32 v40, 16, v60
  v_and_b32 v41, s26, v60
  v_lshlrev_b32 v42, 16, v61
  v_and_b32 v43, s26, v61
  v_max3_f32 v44, v40, v41, v42
  v_max_f32 v44, v44, v43
  s_nop 1
  v_max_f32_dpp v44, v44, v44 row_ror:4 row_mask:0xf bank_mask:0xf
  s_nop 1
  v_max_f32_dpp v44, v44, v44 row_ror:8 row_mask:0xf bank_mask:0xf
  v_mov_b32 v45, v44
  s_nop 1
  v_permlane16_swap_b32 v44, v45
  v_max_f32 v44, v44, v45
  v_mov_b32 v45, v44
  s_nop 1
  v_permlane32_swap_b32 v44, v45
  v_max_f32 v44, v44, v45
  v_mul_f32 v44, s29, v44
  v_max_f32 v44, v44, v18
  v_sub_f32 v45, v18, v44
  v_mov_b32 v18, v44
  v_exp_f32 v45, v45
  v_fma_f32 v40, v40, s29, -v18
  v_fma_f32 v41, v41, s29, -v18
  v_fma_f32 v42, v42, s29, -v18
  v_fma_f32 v43, v43, s29, -v18
  v_exp_f32 v40, v40
  v_exp_f32 v41, v41
  v_exp_f32 v42, v42
  v_exp_f32 v43, v43
  v_mul_f32 v14, v14, v45
  v_mul_f32 v15, v15, v45
  v_mul_f32 v16, v16, v45
  v_mul_f32 v17, v17, v45
  v_fma_f32 v19, v19, v45, v40
  v_add_f32 v44, v41, v42
  v_add_f32 v19, v19, v43
  v_add_f32 v19, v19, v44
  v_cvt_pk_bf16_f32 v40, v40, v40
  v_cvt_pk_bf16_f32 v41, v41, v41
  v_cvt_pk_bf16_f32 v42, v42, v42
  v_cvt_pk_bf16_f32 v43, v43, v43
  v_and_b32_dpp v48, v40, v2 row_newbcast:0 row_mask:0xf bank_mask:0xf
  v_and_b32_dpp v49, v40, v3 row_newbcast:0 row_mask:0xf bank_mask:0xf
  v_and_b32_dpp v50, v40, v4 row_newbcast:0 row_mask:0xf bank_mask:0xf
  v_and_b32_dpp v51, v40, v5 row_newbcast:0 row_mask:0xf bank_mask:0xf
  s_waitcnt vmcnt(31)
  s_nop 0
  v_mfma_f32_16x16x32_bf16 v[14:17], v[48:51], v[64:67], v[14:17]
  v_and_b32_dpp v52, v40, v2 row_newbcast:8 row_mask:0xf bank_mask:0xf
  v_and_b32_dpp v53, v40, v3 row_newbcast:8 row_mask:0xf bank_mask:0xf
  v_and_b32_dpp v54, v40, v4 row_newbcast:8 row_mask:0xf bank_mask:0xf
  v_and_b32_dpp v55, v40, v5 row_newbcast:8 row_mask:0xf bank_mask:0xf
  s_waitcnt vmcnt(30)
  s_nop 0
  v_mfma_f32_16x16x32_bf16 v[14:17], v[52:55], v[68:71], v[14:17]
  v_and_b32_dpp v48, v40, v2 row_newbcast:4 row_mask:0xf bank_mask:0xf
  v_and_b32_dpp v49, v40, v3 row_newbcast:4 row_mask:0xf bank_mask:0xf
  v_and_b32_dpp v50, v40, v4 row_newbcast:4 row_mask:0xf bank_mask:0xf
  v_and_b32_dpp v51, v40, v5 row_newbcast:4 row_mask:0xf bank_mask:0xf
  s_waitcnt vmcnt(29)
  s_nop 0
  v_mfma_f32_16x16x32_bf16 v[14:17], v[48:51], v[72:75], v[14:17]
  v_and_b32_dpp v52, v40, v2 row_newbcast:12 row_mask:0xf bank_mask:0xf
  v_and_b32_dpp v53, v40, v3 row_newbcast:12 row_mask:0xf bank_mask:0xf
  v_and_b32_dpp v54, v40, v4 row_newbcast:12 row_mask:0xf bank_mask:0xf
  v_and_b32_dpp v55, v40, v5 row_newbcast:12 row_mask:0xf bank_mask:0xf
  s_waitcnt vmcnt(28)
  s_nop 0
  v_mfma_f32_16x16x32_bf16 v[14:17], v[52:55], v[76:79], v[14:17]
  v_and_b32_dpp v48, v41, v2 row_newbcast:0 row_mask:0xf bank_mask:0xf
  v_and_b32_dpp v49, v41, v3 row_newbcast:0 row_mask:0xf bank_mask:0xf
  v_and_b32_dpp v50, v41, v4 row_newbcast:0 row_mask:0xf bank_mask:0xf
  v_and_b32_dpp v51, v41, v5 row_newbcast:0 row_mask:0xf bank_mask:0xf
  s_waitcnt vmcnt(27)
  s_nop 0
  v_mfma_f32_16x16x32_bf16 v[14:17], v[48:51], v[80:83], v[14:17]
  v_and_b32_dpp v52, v41, v2 row_newbcast:8 row_mask:0xf bank_mask:0xf
  v_and_b32_dpp v53, v41, v3 row_newbcast:8 row_mask:0xf bank_mask:0xf
  v_and_b32_dpp v54, v41, v4 row_newbcast:8 row_mask:0xf bank_mask:0xf
  v_and_b32_dpp v55, v41, v5 row_newbcast:8 row_mask:0xf bank_mask:0xf
  s_waitcnt vmcnt(26)
  s_nop 0
  v_mfma_f32_16x16x32_bf16 v[14:17], v[52:55], v[84:87], v[14:17]
  v_and_b32_dpp v48, v41, v2 row_newbcast:4 row_mask:0xf bank_mask:0xf
  v_and_b32_dpp v49, v41, v3 row_newbcast:4 row_mask:0xf bank_mask:0xf
  v_and_b32_dpp v50, v41, v4 row_newbcast:4 row_mask:0xf bank_mask:0xf
  v_and_b32_dpp v51, v41, v5 row_newbcast:4 row_mask:0xf bank_mask:0xf
  s_waitcnt vmcnt(25)
  s_nop 0
  v_mfma_f32_16x16x32_bf16 v[14:17], v[48:51], v[88:91], v[14:17]
  v_and_b32_dpp v52, v41, v2 row_newbcast:12 row_mask:0xf bank_mask:0xf
  v_and_b32_dpp v53, v41, v3 row_newbcast:12 row_mask:0xf bank_mask:0xf
  v_and_b32_dpp v54, v41, v4 row_newbcast:12 row_mask:0xf bank_mask:0xf
  v_and_b32_dpp v55, v41, v5 row_newbcast:12 row_mask:0xf bank_mask:0xf
  s_waitcnt vmcnt(24)
  s_nop 0
  v_mfma_f32_16x16x32_bf16 v[14:17], v[52:55], v[92:95], v[14:17]
  v_and_b32_dpp v48, v42, v2 row_newbcast:0 row_mask:0xf bank_mask:0xf
  v_and_b32_dpp v49, v42, v3 row_newbcast:0 row_mask:0xf bank_mask:0xf
  v_and_b32_dpp v50, v42, v4 row_newbcast:0 row_mask:0xf bank_mask:0xf
  v_and_b32_dpp v51, v42, v5 row_newbcast:0 row_mask:0xf bank_mask:0xf
  s_waitcnt vmcnt(23)
  s_nop 0
  v_mfma_f32_16x16x32_bf16 v[14:17], v[48:51], v[96:99], v[14:17]
  v_and_b32_dpp v52, v42, v2 row_newbcast:8 row_mask:0xf bank_mask:0xf
  v_and_b32_dpp v53, v42, v3 row_newbcast:8 row_mask:0xf bank_mask:0xf
  v_and_b32_dpp v54, v42, v4 row_newbcast:8 row_mask:0xf bank_mask:0xf
  v_and_b32_dpp v55, v42, v5 row_newbcast:8 row_mask:0xf bank_mask:0xf
  s_waitcnt vmcnt(22)
  s_nop 0
  v_mfma_f32_16x16x32_bf16 v[14:17], v[52:55], v[100:103], v[14:17]
  v_and_b32_dpp v48, v42, v2 row_newbcast:4 row_mask:0xf bank_mask:0xf
  v_and_b32_dpp v49, v42, v3 row_newbcast:4 row_mask:0xf bank_mask:0xf
  v_and_b32_dpp v50, v42, v4 row_newbcast:4 row_mask:0xf bank_mask:0xf
  v_and_b32_dpp v51, v42, v5 row_newbcast:4 row_mask:0xf bank_mask:0xf
  s_waitcnt vmcnt(21)
  s_nop 0
  v_mfma_f32_16x16x32_bf16 v[14:17], v[48:51], v[104:107], v[14:17]
  v_and_b32_dpp v52, v42, v2 row_newbcast:12 row_mask:0xf bank_mask:0xf
  v_and_b32_dpp v53, v42, v3 row_newbcast:12 row_mask:0xf bank_mask:0xf
  v_and_b32_dpp v54, v42, v4 row_newbcast:12 row_mask:0xf bank_mask:0xf
  v_and_b32_dpp v55, v42, v5 row_newbcast:12 row_mask:0xf bank_mask:0xf
  s_waitcnt vmcnt(20)
  s_nop 0
  v_mfma_f32_16x16x32_bf16 v[14:17], v[52:55], v[108:111], v[14:17]
  v_and_b32_dpp v48, v43, v2 row_newbcast:0 row_mask:0xf bank_mask:0xf
  v_and_b32_dpp v49, v43, v3 row_newbcast:0 row_mask:0xf bank_mask:0xf
  v_and_b32_dpp v50, v43, v4 row_newbcast:0 row_mask:0xf bank_mask:0xf
  v_and_b32_dpp v51, v43, v5 row_newbcast:0 row_mask:0xf bank_mask:0xf
  s_waitcnt vmcnt(19)
  s_nop 0
  v_mfma_f32_16x16x32_bf16 v[14:17], v[48:51], v[112:115], v[14:17]
  v_and_b32_dpp v52, v43, v2 row_newbcast:8 row_mask:0xf bank_mask:0xf
  v_and_b32_dpp v53, v43, v3 row_newbcast:8 row_mask:0xf bank_mask:0xf
  v_and_b32_dpp v54, v43, v4 row_newbcast:8 row_mask:0xf bank_mask:0xf
  v_and_b32_dpp v55, v43, v5 row_newbcast:8 row_mask:0xf bank_mask:0xf
  s_waitcnt vmcnt(18)
  s_nop 0
  v_mfma_f32_16x16x32_bf16 v[14:17], v[52:55], v[116:119], v[14:17]
  v_and_b32_dpp v48, v43, v2 row_newbcast:4 row_mask:0xf bank_mask:0xf
  v_and_b32_dpp v49, v43, v3 row_newbcast:4 row_mask:0xf bank_mask:0xf
  v_and_b32_dpp v50, v43, v4 row_newbcast:4 row_mask:0xf bank_mask:0xf
  v_and_b32_dpp v51, v43, v5 row_newbcast:4 row_mask:0xf bank_mask:0xf
  s_waitcnt vmcnt(17)
  s_nop 0
  v_mfma_f32_16x16x32_bf16 v[14:17], v[48:51], v[120:123], v[14:17]
  v_and_b32_dpp v52, v43, v2 row_newbcast:12 row_mask:0xf bank_mask:0xf
  v_and_b32_dpp v53, v43, v3 row_newbcast:12 row_mask:0xf bank_mask:0xf
  v_and_b32_dpp v54, v43, v4 row_newbcast:12 row_mask:0xf bank_mask:0xf
  v_and_b32_dpp v55, v43, v5 row_newbcast:12 row_mask:0xf bank_mask:0xf
  s_waitcnt vmcnt(16)
  s_nop 0
  v_mfma_f32_16x16x32_bf16 v[14:17], v[52:55], v[124:127], v[14:17]
  s_cmp_lt_u32 s25, s53
  s_cbranch_scc1 L_vst
  v_readfirstlane_b32 s7, v22
  s_mov_b64 s[8:9], s[48:49]
  s_mov_b64 s[40:41], s[48:49]
  s_mov_b64 s[12:13], s[50:51]
  s_mov_b64 s[44:45], s[50:51]
  s_add_u32 s67, s7, 232
  s_cmp_lt_u32 s7, 4
  s_cbranch_scc1 L_vst
  s_mov_b32 s61, 0xff800000
  s_mov_b32 s42, 0
  s_add_u32 s67, s7, 468
  s_bitcmp1_b32 s67, 0
  s_cselect_b32 s64, 131072, 0
  s_xor_b32 s64, s64, s63
  s_lshr_b32 s67, s67, 1
  s_cmp_lt_u32 s7, 44
  s_cselect_b32 s10, s10, 0
L_vst:
  s_bfe_u32 s24, s67, 0x10000
  s_lshl_b32 s24, s24, 18
  s_bfe_u32 s62, s67, 0x10001
  s_lshl_b32 s62, s62, 11
  s_or_b32 s24, s24, s62
  s_bfe_u32 s62, s67, 0x10002
  s_lshl_b32 s62, s62, 14
  s_or_b32 s24, s24, s62
  s_bfe_u32 s62, s67, 0x20003
  s_lshl_b32 s62, s62, 9
  s_or_b32 s24, s24, s62
  s_bfe_u32 s62, s67, 0x30005
  s_lshl_b32 s62, s62, 19
  s_or_b32 s24, s24, s62
  s_xor_b32 s24, s24, s64
  s_xor_b32 s66, s24, 4096
  buffer_load_dwordx4 v[64:67], v6, s[8:11], s24 offen offset:0 nt
  buffer_load_dwordx4 v[68:71], v6, s[8:11], s24 offen offset:256 nt
  buffer_load_dwordx4 v[72:75], v6, s[8:11], s66 offen offset:0 nt
  buffer_load_dwordx4 v[76:79], v6, s[8:11], s66 offen offset:256 nt
  buffer_load_dwordx4 v[80:83], v7, s[8:11], s24 offen offset:0 nt
  buffer_load_dwordx4 v[84:87], v7, s[8:11], s24 offen offset:256 nt
  buffer_load_dwordx4 v[88:91], v7, s[8:11], s66 offen offset:0 nt
  buffer_load_dwordx4 v[92:95], v7, s[8:11], s66 offen offset:256 nt
  buffer_load_dwordx4 v[96:99], v8, s[40:43], s24 offen offset:0 nt
  buffer_load_dwordx4 v[100:103], v8, s[40:43], s24 offen offset:256 nt
  buffer_load_dwordx4 v[104:107], v8, s[40:43], s66 offen offset:0 nt
  buffer_load_dwordx4 v[108:111], v8, s[40:43], s66 offen offset:256 nt
  buffer_load_dwordx4 v[112:115], v9, s[40:43], s24 offen offset:0 nt
  buffer_load_dwordx4 v[116:119], v9, s[40:43], s24 offen offset:256 nt
  buffer_load_dwordx4 v[120:123], v9, s[40:43], s66 offen offset:0 nt
  buffer_load_dwordx4 v[124:127], v9, s[40:43], s66 offen offset:256 nt
  v_lshlrev_b32 v40, 16, v62
  v_and_b32 v41, s26, v62
  v_lshlrev_b32 v42, 16, v63
  v_and_b32 v43, s26, v63
  v_max3_f32 v44, v40, v41, v42
  v_max_f32 v44, v44, v43
  s_nop 1
  v_max_f32_dpp v44, v44, v44 row_ror:4 row_mask:0xf bank_mask:0xf
  s_nop 1
  v_max_f32_dpp v44, v44, v44 row_ror:8 row_mask:0xf bank_mask:0xf
  v_mov_b32 v45, v44
  s_nop 1
  v_permlane16_swap_b32 v44, v45
  v_max_f32 v44, v44, v45
  v_mov_b32 v45, v44
  s_nop 1
  v_permlane32_swap_b32 v44, v45
  v_max_f32 v44, v44, v45
  v_mul_f32 v44, s29, v44
  v_max_f32 v44, v44, v18
  v_sub_f32 v45, v18, v44
  v_mov_b32 v18, v44
  v_exp_f32 v45, v45
  v_fma_f32 v40, v40, s29, -v18
  v_fma_f32 v41, v41, s29, -v18
  v_fma_f32 v42, v42, s29, -v18
  v_fma_f32 v43, v43, s29, -v18
  v_exp_f32 v40, v40
  v_exp_f32 v41, v41
  v_exp_f32 v42, v42
  v_exp_f32 v43, v43
  v_mul_f32 v14, v14, v45
  v_mul_f32 v15, v15, v45
  v_mul_f32 v16, v16, v45
  v_mul_f32 v17, v17, v45
  v_fma_f32 v19, v19, v45, v40
  v_add_f32 v44, v41, v42
  v_add_f32 v19, v19, v43
  v_add_f32 v19, v19, v44
  v_cvt_pk_bf16_f32 v40, v40, v40
  v_cvt_pk_bf16_f32 v41, v41, v41
  v_cvt_pk_bf16_f32 v42, v42, v42
  v_cvt_pk_bf16_f32 v43, v43, v43
  v_and_b32_dpp v48, v40, v2 row_newbcast:0 row_mask:0xf bank_mask:0xf
  v_and_b32_dpp v49, v40, v3 row_newbcast:0 row_mask:0xf bank_mask:0xf
  v_and_b32_dpp v50, v40, v4 row_newbcast:0 row_mask:0xf bank_mask:0xf
  v_and_b32_dpp v51, v40, v5 row_newbcast:0 row_mask:0xf bank_mask:0xf
  s_waitcnt vmcnt(31)
  s_nop 0
  v_mfma_f32_16x16x32_bf16 v[14:17], v[48:51], v[128:131], v[14:17]
  v_and_b32_dpp v52, v40, v2 row_newbcast:8 row_mask:0xf bank_mask:0xf
  v_and_b32_dpp v53, v40, v3 row_newbcast:8 row_mask:0xf bank_mask:0xf
  v_and_b32_dpp v54, v40, v4 row_newbcast:8 row_mask:0xf bank_mask:0xf
  v_and_b32_dpp v55, v40, v5 row_newbcast:8 row_mask:0xf bank_mask:0xf
  s_waitcnt vmcnt(30)
  s_nop 0
  v_mfma_f32_16x16x32_bf16 v[14:17], v[52:55], v[132:135], v[14:17]
  v_and_b32_dpp v48, v40, v2 row_newbcast:4 row_mask:0xf bank_mask:0xf
  v_and_b32_dpp v49, v40, v3 row_newbcast:4 row_mask:0xf bank_mask:0xf
  v_and_b32_dpp v50, v40, v4 row_newbcast:4 row_mask:0xf bank_mask:0xf
  v_and_b32_dpp v51, v40, v5 row_newbcast:4 row_mask:0xf bank_mask:0xf
  s_waitcnt vmcnt(29)
  s_nop 0
  v_mfma_f32_16x16x32_bf16 v[14:17], v[48:51], v[136:139], v[14:17]
  v_and_b32_dpp v52, v40, v2 row_newbcast:12 row_mask:0xf bank_mask:0xf
  v_and_b32_dpp v53, v40, v3 row_newbcast:12 row_mask:0xf bank_mask:0xf
  v_and_b32_dpp v54, v40, v4 row_newbcast:12 row_mask:0xf bank_mask:0xf
  v_and_b32_dpp v55, v40, v5 row_newbcast:12 row_mask:0xf bank_mask:0xf
  s_waitcnt vmcnt(28)
  s_nop 0
  v_mfma_f32_16x16x32_bf16 v[14:17], v[52:55], v[140:143], v[14:17]
  v_and_b32_dpp v48, v41, v2 row_newbcast:0 row_mask:0xf bank_mask:0xf
  v_and_b32_dpp v49, v41, v3 row_newbcast:0 row_mask:0xf bank_mask:0xf
  v_and_b32_dpp v50, v41, v4 row_newbcast:0 row_mask:0xf bank_mask:0xf
  v_and_b32_dpp v51, v41, v5 row_newbcast:0 row_mask:0xf bank_mask:0xf
  s_waitcnt vmcnt(27)
  s_nop 0
  v_mfma_f32_16x16x32_bf16 v[14:17], v[48:51], v[144:147], v[14:17]
  v_and_b32_dpp v52, v41, v2 row_newbcast:8 row_mask:0xf bank_mask:0xf
  v_and_b32_dpp v53, v41, v3 row_newbcast:8 row_mask:0xf bank_mask:0xf
  v_and_b32_dpp v54, v41, v4 row_newbcast:8 row_mask:0xf bank_mask:0xf
  v_and_b32_dpp v55, v41, v5 row_newbcast:8 row_mask:0xf bank_mask:0xf
  s_waitcnt vmcnt(26)
  s_nop 0
  v_mfma_f32_16x16x32_bf16 v[14:17], v[52:55], v[148:151], v[14:17]
  v_and_b32_dpp v48, v41, v2 row_newbcast:4 row_mask:0xf bank_mask:0xf
  v_and_b32_dpp v49, v41, v3 row_newbcast:4 row_mask:0xf bank_mask:0xf
  v_and_b32_dpp v50, v41, v4 row_newbcast:4 row_mask:0xf bank_mask:0xf
  v_and_b32_dpp v51, v41, v5 row_newbcast:4 row_mask:0xf bank_mask:0xf
  s_waitcnt vmcnt(25)
  s_nop 0
  v_mfma_f32_16x16x32_bf16 v[14:17], v[48:51], v[152:155], v[14:17]
  v_and_b32_dpp v52, v41, v2 row_newbcast:12 row_mask:0xf bank_mask:0xf
  v_and_b32_dpp v53, v41, v3 row_newbcast:12 row_mask:0xf bank_mask:0xf
  v_and_b32_dpp v54, v41, v4 row_newbcast:12 row_mask:0xf bank_mask:0xf
  v_and_b32_dpp v55, v41, v5 row_newbcast:12 row_mask:0xf bank_mask:0xf
  s_waitcnt vmcnt(24)
  s_nop 0
  v_mfma_f32_16x16x32_bf16 v[14:17], v[52:55], v[156:159], v[14:17]
  v_and_b32_dpp v48, v42, v2 row_newbcast:0 row_mask:0xf bank_mask:0xf
  v_and_b32_dpp v49, v42, v3 row_newbcast:0 row_mask:0xf bank_mask:0xf
  v_and_b32_dpp v50, v42, v4 row_newbcast:0 row_mask:0xf bank_mask:0xf
  v_and_b32_dpp v51, v42, v5 row_newbcast:0 row_mask:0xf bank_mask:0xf
  s_waitcnt vmcnt(23)
  s_nop 0
  v_mfma_f32_16x16x32_bf16 v[14:17], v[48:51], v[160:163], v[14:17]
  v_and_b32_dpp v52, v42, v2 row_newbcast:8 row_mask:0xf bank_mask:0xf
  v_and_b32_dpp v53, v42, v3 row_newbcast:8 row_mask:0xf bank_mask:0xf
  v_and_b32_dpp v54, v42, v4 row_newbcast:8 row_mask:0xf bank_mask:0xf
  v_and_b32_dpp v55, v42, v5 row_newbcast:8 row_mask:0xf bank_mask:0xf
  s_waitcnt vmcnt(22)
  s_nop 0
  v_mfma_f32_16x16x32_bf16 v[14:17], v[52:55], v[164:167], v[14:17]
  v_and_b32_dpp v48, v42, v2 row_newbcast:4 row_mask:0xf bank_mask:0xf
  v_and_b32_dpp v49, v42, v3 row_newbcast:4 row_mask:0xf bank_mask:0xf
  v_and_b32_dpp v50, v42, v4 row_newbcast:4 row_mask:0xf bank_mask:0xf
  v_and_b32_dpp v51, v42, v5 row_newbcast:4 row_mask:0xf bank_mask:0xf
  s_waitcnt vmcnt(21)
  s_nop 0
  v_mfma_f32_16x16x32_bf16 v[14:17], v[48:51], v[168:171], v[14:17]
  v_and_b32_dpp v52, v42, v2 row_newbcast:12 row_mask:0xf bank_mask:0xf
  v_and_b32_dpp v53, v42, v3 row_newbcast:12 row_mask:0xf bank_mask:0xf
  v_and_b32_dpp v54, v42, v4 row_newbcast:12 row_mask:0xf bank_mask:0xf
  v_and_b32_dpp v55, v42, v5 row_newbcast:12 row_mask:0xf bank_mask:0xf
  s_waitcnt vmcnt(20)
  s_nop 0
  v_mfma_f32_16x16x32_bf16 v[14:17], v[52:55], v[172:175], v[14:17]
  v_and_b32_dpp v48, v43, v2 row_newbcast:0 row_mask:0xf bank_mask:0xf
  v_and_b32_dpp v49, v43, v3 row_newbcast:0 row_mask:0xf bank_mask:0xf
  v_and_b32_dpp v50, v43, v4 row_newbcast:0 row_mask:0xf bank_mask:0xf
  v_and_b32_dpp v51, v43, v5 row_newbcast:0 row_mask:0xf bank_mask:0xf
  s_waitcnt vmcnt(19)
  s_nop 0
  v_mfma_f32_16x16x32_bf16 v[14:17], v[48:51], v[176:179], v[14:17]
  v_and_b32_dpp v52, v43, v2 row_newbcast:8 row_mask:0xf bank_mask:0xf
  v_and_b32_dpp v53, v43, v3 row_newbcast:8 row_mask:0xf bank_mask:0xf
  v_and_b32_dpp v54, v43, v4 row_newbcast:8 row_mask:0xf bank_mask:0xf
  v_and_b32_dpp v55, v43, v5 row_newbcast:8 row_mask:0xf bank_mask:0xf
  s_waitcnt vmcnt(18)
  s_nop 0
  v_mfma_f32_16x16x32_bf16 v[14:17], v[52:55], v[180:183], v[14:17]
  v_and_b32_dpp v48, v43, v2 row_newbcast:4 row_mask:0xf bank_mask:0xf
  v_and_b32_dpp v49, v43, v3 row_newbcast:4 row_mask:0xf bank_mask:0xf
  v_and_b32_dpp v50, v43, v4 row_newbcast:4 row_mask:0xf bank_mask:0xf
  v_and_b32_dpp v51, v43, v5 row_newbcast:4 row_mask:0xf bank_mask:0xf
  s_waitcnt vmcnt(17)
  s_nop 0
  v_mfma_f32_16x16x32_bf16 v[14:17], v[48:51], v[184:187], v[14:17]
  v_and_b32_dpp v52, v43, v2 row_newbcast:12 row_mask:0xf bank_mask:0xf
  v_and_b32_dpp v53, v43, v3 row_newbcast:12 row_mask:0xf bank_mask:0xf
  v_and_b32_dpp v54, v43, v4 row_newbcast:12 row_mask:0xf bank_mask:0xf
  v_and_b32_dpp v55, v43, v5 row_newbcast:12 row_mask:0xf bank_mask:0xf
  s_waitcnt vmcnt(16)
  s_nop 0
  v_mfma_f32_16x16x32_bf16 v[14:17], v[52:55], v[188:191], v[14:17]
  s_cmp_eq_u32 s25, s53
  s_cbranch_scc1 L_tail
  s_mov_b32 s69, 1
  v_mov_b32 v22, 1
  s_cmp_lg_u32 s25, s52
  s_cbranch_scc1 L_vnoat
  buffer_atomic_add v22, v20, s[20:23], 0 offen offset:128 sc0 sc1
L_vnoat:
  buffer_load_dwordx4 v[128:131], v6, s[12:15], s24 offen offset:0 nt
  buffer_load_dwordx4 v[132:135], v6, s[12:15], s24 offen offset:256 nt
  buffer_load_dwordx4 v[136:139], v6, s[12:15], s66 offen offset:0 nt
  buffer_load_dwordx4 v[140:143], v6, s[12:15], s66 offen offset:256 nt
  buffer_load_dwordx4 v[144:147], v7, s[12:15], s24 offen offset:0 nt
  buffer_load_dwordx4 v[148:151], v7, s[12:15], s24 offen offset:256 nt
  buffer_load_dwordx4 v[152:155], v7, s[12:15], s66 offen offset:0 nt
  buffer_load_dwordx4 v[156:159], v7, s[12:15], s66 offen offset:256 nt
  buffer_load_dwordx4 v[160:163], v8, s[44:47], s24 offen offset:0 nt
  buffer_load_dwordx4 v[164:167], v8, s[44:47], s24 offen offset:256 nt
  buffer_load_dwordx4 v[168:171], v8, s[44:47], s66 offen offset:0 nt
  buffer_load_dwordx4 v[172:175], v8, s[44:47], s66 offen offset:256 nt
  buffer_load_dwordx4 v[176:179], v9, s[44:47], s24 offen offset:0 nt
  buffer_load_dwordx4 v[180:183], v9, s[44:47], s24 offen offset:256 nt
  buffer_load_dwordx4 v[184:187], v9, s[44:47], s66 offen offset:0 nt
  buffer_load_dwordx4 v[188:191], v9, s[44:47], s66 offen offset:256 nt
  s_branch L_vloop
L_loop:
  s_waitcnt vmcnt(31)
  v_dot2_f32_bf16 v24, v64, v10, 0
  v_dot2_f32_bf16 v24, v65, v11, v24
  v_dot2_f32_bf16 v24, v66, v12, v24
  v_dot2_f32_bf16 v24, v67, v13, v24
  s_waitcnt vmcnt(30)
  v_dot2_f32_bf16 v25, v68, v10, 0
  v_dot2_f32_bf16 v25, v69, v11, v25
  v_dot2_f32_bf16 v25, v70, v12, v25
  v_dot2_f32_bf16 v25, v71, v13, v25
  s_waitcnt vmcnt(29)
  v_dot2_f32_bf16 v26, v72, v10, 0
  v_dot2_f32_bf16 v26, v73, v11, v26
  v_dot2_f32_bf16 v26, v74, v12, v26
  v_dot2_f32_bf16 v26, v75, v13, v26
  s_waitcnt vmcnt(28)
  v_dot2_f32_bf16 v27, v76, v10, 0
  v_dot2_f32_bf16 v27, v77, v11, v27
  v_dot2_f32_bf16 v27, v78, v12, v27
  v_dot2_f32_bf16 v27, v79, v13, v27
  s_waitcnt vmcnt(27)
  v_dot2_f32_bf16 v28, v80, v10, 0
  v_dot2_f32_bf16 v28, v81, v11, v28
  v_dot2_f32_bf16 v28, v82, v12, v28
  v_dot2_f32_bf16 v28, v83, v13, v28
  v_add_f32_dpp v24, v24, v24 row_ror:8 row_mask:0xf bank_mask:0x3
  v_add_f32_dpp v26, v26, v26 row_ror:8 row_mask:0xf bank_mask:0x3
  s_nop 0
  v_add_f32_dpp v24, v25, v25 row_ror:8 row_mask:0xf bank_mask:0xc
  v_add_f32_dpp v26, v27, v27 row_ror:8 row_mask:0xf bank_mask:0xc
  s_waitcnt vmcnt(26)
  v_dot2_f32_bf16 v29, v84, v10, 0
  v_dot2_f32_bf16 v29, v85, v11, v29
  v_dot2_f32_bf16 v29, v86, v12, v29
  v_dot2_f32_bf16 v29, v87, v13, v29
  v_add_f32_dpp v40, v24, v24 row_shl:4 row_mask:0xf bank_mask:0x5
  s_nop 1
  v_add_f32_dpp v40, v26, v26 row_shr:4 row_mask:0xf bank_mask:0xa
  s_waitcnt vmcnt(25)
  v_dot2_f32_bf16 v30, v88, v10, 0
  v_dot2_f32_bf16 v30, v89, v11, v30
  v_dot2_f32_bf16 v30, v90, v12, v30
  v_dot2_f32_bf16 v30, v91, v13, v30
  s_waitcnt vmcnt(24)
  v_dot2_f32_bf16 v31, v92, v10, 0
  v_dot2_f32_bf16 v31, v93, v11, v31
  v_dot2_f32_bf16 v31, v94, v12, v31
  v_dot2_f32_bf16 v31, v95, v13, v31
  s_waitcnt vmcnt(23)
  v_dot2_f32_bf16 v32, v96, v10, 0
  v_dot2_f32_bf16 v32, v97, v11, v32
  v_dot2_f32_bf16 v32, v98, v12, v32
  v_dot2_f32_bf16 v32, v99, v13, v32
  v_add_f32_dpp v28, v28, v28 row_ror:8 row_mask:0xf bank_mask:0x3
  v_add_f32_dpp v30, v30, v30 row_ror:8 row_mask:0xf bank_mask:0x3
  s_nop 0
  v_add_f32_dpp v28, v29, v29 row_ror:8 row_mask:0xf bank_mask:0xc
  v_add_f32_dpp v30, v31, v31 row_ror:8 row_mask:0xf bank_mask:0xc
  s_waitcnt vmcnt(22)
  v_dot2_f32_bf16 v33, v100, v10, 0
  v_dot2_f32_bf16 v33, v101, v11, v33
  v_dot2_f32_bf16 v33, v102, v12, v33
  v_dot2_f32_bf16 v33, v103, v13, v33
  v_add_f32_dpp v41, v28, v28 row_shl:4 row_mask:0xf bank_mask:0x5
  s_nop 1
  v_add_f32_dpp v41, v30, v30 row_shr:4 row_mask:0xf bank_mask:0xa
  s_waitcnt vmcnt(21)
  v_dot2_f32_bf16 v34, v104, v10, 0
  v_dot2_f32_bf16 v34, v105, v11, v34
  v_dot2_f32_bf16 v34, v106, v12, v34
  v_dot2_f32_bf16 v34, v107, v13, v34
  s_waitcnt vmcnt(20)
  v_dot2_f32_bf16 v35, v108, v10, 0
  v_dot2_f32_bf16 v35, v109, v11, v35
  v_dot2_f32_bf16 v35, v110, v12, v35
  v_dot2_f32_bf16 v35, v111, v13, v35
  s_waitcnt vmcnt(19)
  v_dot2_f32_bf16 v36, v112, v10, 0
  v_dot2_f32_bf16 v36, v113, v11, v36
  v_dot2_f32_bf16 v36, v114, v12, v36
  v_dot2_f32_bf16 v36, v115, v13, v36
  v_add_f32_dpp v32, v32, v32 row_ror:8 row_mask:0xf bank_mask:0x3
  v_add_f32_dpp v34, v34, v34 row_ror:8 row_mask:0xf bank_mask:0x3
  s_nop 0
  v_add_f32_dpp v32, v33, v33 row_ror:8 row_mask:0xf bank_mask:0xc
  v_add_f32_dpp v34, v35, v35 row_ror:8 row_mask:0xf bank_mask:0xc
  s_waitcnt vmcnt(18)
  v_dot2_f32_bf16 v37, v116, v10, 0
  v_dot2_f32_bf16 v37, v117, v11, v37
  v_dot2_f32_bf16 v37, v118, v12, v37
  v_dot2_f32_bf16 v37, v119, v13, v37
  v_add_f32_dpp v42, v32, v32 row_shl:4 row_mask:0xf bank_mask:0x5
  s_nop 1
  v_add_f32_dpp v42, v34, v34 row_shr:4 row_mask:0xf bank_mask:0xa
  s_waitcnt vmcnt(17)
  v_dot2_f32_bf16 v38, v120, v10, 0
  v_dot2_f32_bf16 v38, v121, v11, v38
  v_dot2_f32_bf16 v38, v122, v12, v38
  v_dot2_f32_bf16 v38, v123, v13, v38
  s_waitcnt vmcnt(16)
  v_dot2_f32_bf16 v39, v124, v10, 0
  v_dot2_f32_bf16 v39, v125, v11, v39
  v_dot2_f32_bf16 v39, v126, v12, v39
  v_dot2_f32_bf16 v39, v127, v13, v39
  v_readfirstlane_b32 s7, v22
  s_add_u32 s67, s67, 32
  s_add_u32 s25, s25, 1
  s_mov_b32 s60, s61
  s_add_u32 s67, s7, 232
  s_cmp_lt_u32 s7, 4
  s_cbranch_scc1 L_stat
  s_mov_b32 s61, 0xff800000
  s_mov_b32 s42, 0
  s_add_u32 s67, s7, 468
  s_bitcmp1_b32 s67, 0
  s_cselect_b32 s64, 131072, 0
  s_xor_b32 s64, s64, s63
  s_lshr_b32 s67, s67, 1
  s_cmp_lt_u32 s7, 44
  s_cselect_b32 s10, s10, 0
L_stat:
  s_bfe_u32 s24, s67, 0x10000
  s_lshl_b32 s24, s24, 18
  s_bfe_u32 s62, s67, 0x10001
  s_lshl_b32 s62, s62, 11
  s_or_b32 s24, s24, s62
  s_bfe_u32 s62, s67, 0x10002
  s_lshl_b32 s62, s62, 14
  s_or_b32 s24, s24, s62
  s_bfe_u32 s62, s67, 0x20003
  s_lshl_b32 s62, s62, 9
  s_or_b32 s24, s24, s62
  s_bfe_u32 s62, s67, 0x30005
  s_lshl_b32 s62, s62, 19
  s_or_b32 s24, s24, s62
  s_xor_b32 s24, s24, s64
  s_xor_b32 s66, s24, 4096
  buffer_load_dwordx4 v[64:67], v6, s[8:11], s24 offen offset:0 nt
  buffer_load_dwordx4 v[68:71], v6, s[8:11], s24 offen offset:256 nt
  buffer_load_dwordx4 v[72:75], v6, s[8:11], s66 offen offset:0 nt
  buffer_load_dwordx4 v[76:79], v6, s[8:11], s66 offen offset:256 nt
  buffer_load_dwordx4 v[80:83], v7, s[8:11], s24 offen offset:0 nt
  buffer_load_dwordx4 v[84:87], v7, s[8:11], s24 offen offset:256 nt
  buffer_load_dwordx4 v[88:91], v7, s[8:11], s66 offen offset:0 nt
  buffer_load_dwordx4 v[92:95], v7, s[8:11], s66 offen offset:256 nt
  buffer_load_dwordx4 v[96:99], v8, s[40:43], s24 offen offset:0 nt
  buffer_load_dwordx4 v[100:103], v8, s[40:43], s24 offen offset:256 nt
  buffer_load_dwordx4 v[104:107], v8, s[40:43], s66 offen offset:0 nt
  buffer_load_dwordx4 v[108:111], v8, s[40:43], s66 offen offset:256 nt
  buffer_load_dwordx4 v[112:115], v9, s[40:43], s24 offen offset:0 nt
  buffer_load_dwordx4 v[116:119], v9, s[40:43], s24 offen offset:256 nt
  buffer_load_dwordx4 v[120:123], v9, s[40:43], s66 offen offset:0 nt
  buffer_load_dwordx4 v[124:127], v9, s[40:43], s66 offen offset:256 nt
  v_add_f32_dpp v36, v36, v36 row_ror:8 row_mask:0xf bank_mask:0x3
  v_add_f32_dpp v38, v38, v38 row_ror:8 row_mask:0xf bank_mask:0x3
  s_nop 0
  v_add_f32_dpp v36, v37, v37 row_ror:8 row_mask:0xf bank_mask:0xc
  v_add_f32_dpp v38, v39, v39 row_ror:8 row_mask:0xf bank_mask:0xc
  s_nop 0
  v_add_f32_dpp v43, v36, v36 row_shl:4 row_mask:0xf bank_mask:0x5
  s_nop 1
  v_add_f32_dpp v43, v38, v38 row_shr:4 row_mask:0xf bank_mask:0xa
  v_add_f32_dpp v40, v40, v40 quad_perm:[1,0,3,2] row_mask:0xf bank_mask:0xf
  v_add_f32_dpp v41, v41, v41 quad_perm:[1,0,3,2] row_mask:0xf bank_mask:0xf
  v_add_f32_dpp v42, v42, v42 quad_perm:[1,0,3,2] row_mask:0xf bank_mask:0xf
  v_add_f32_dpp v43, v43, v43 quad_perm:[1,0,3,2] row_mask:0xf bank_mask:0xf
  v_add_f32_dpp v40, v40, v40 quad_perm:[2,3,0,1] row_mask:0xf bank_mask:0xf
  v_add_f32_dpp v41, v41, v41 quad_perm:[2,3,0,1] row_mask:0xf bank_mask:0xf
  v_add_f32_dpp v42, v42, v42 quad_perm:[2,3,0,1] row_mask:0xf bank_mask:0xf
  v_add_f32_dpp v43, v43, v43 quad_perm:[2,3,0,1] row_mask:0xf bank_mask:0xf
  v_cvt_pk_bf16_f32 v44, v40, v41
  v_cvt_pk_bf16_f32 v45, v42, v43
  v_lshlrev_b32 v40, 16, v44
  v_and_b32 v41, s26, v44
  v_lshlrev_b32 v42, 16, v45
  v_and_b32 v43, s26, v45
  v_mul_f32 v40, s28, v40
  v_mul_f32 v41, s28, v41
  v_mul_f32 v42, s28, v42
  v_mul_f32 v43, s28, v43
  v_cvt_pk_bf16_f32 v44, v40, v41
  v_cvt_pk_bf16_f32 v45, v42, v43
  v_lshlrev_b32 v40, 16, v44
  v_and_b32 v41, s26, v44
  v_lshlrev_b32 v42, 16, v45
  v_and_b32 v43, s26, v45
  v_add_f32 v42, s60, v42
  v_add_f32 v43, s60, v43
  v_max3_f32 v44, v40, v41, v42
  v_max_f32 v44, v44, v43
  s_nop 1
  v_max_f32_dpp v44, v44, v44 row_ror:4 row_mask:0xf bank_mask:0xf
  s_nop 1
  v_max_f32_dpp v44, v44, v44 row_ror:8 row_mask:0xf bank_mask:0xf
  v_mov_b32 v45, v44
  s_nop 1
  v_permlane16_swap_b32 v44, v45
  v_max_f32 v44, v44, v45
  v_mov_b32 v45, v44
  s_nop 1
  v_permlane32_swap_b32 v44, v45
  v_max_f32 v44, v44, v45
  v_mul_f32 v44, s29, v44
  v_max_f32 v44, v44, v18
  v_sub_f32 v45, v18, v44
  v_mov_b32 v18, v44
  v_exp_f32 v45, v45
  v_fma_f32 v40, v40, s29, -v18
  v_fma_f32 v41, v41, s29, -v18
  v_fma_f32 v42, v42, s29, -v18
  v_fma_f32 v43, v43, s29, -v18
  v_exp_f32 v40, v40
  v_exp_f32 v41, v41
  v_exp_f32 v42, v42
  v_exp_f32 v43, v43
  v_mul_f32 v14, v14, v45
  v_mul_f32 v15, v15, v45
  v_mul_f32 v16, v16, v45
  v_mul_f32 v17, v17, v45
  v_fma_f32 v19, v19, v45, v40
  v_add_f32 v44, v41, v42
  v_add_f32 v19, v19, v43
  v_add_f32 v19, v19, v44
  v_cvt_pk_bf16_f32 v40, v40, v40
  v_cvt_pk_bf16_f32 v41, v41, v41
  v_cvt_pk_bf16_f32 v42, v42, v42
  v_cvt_pk_bf16_f32 v43, v43, v43
  v_and_b32_dpp v48, v40, v2 row_newbcast:0 row_mask:0xf bank_mask:0xf
  v_and_b32_dpp v49, v40, v3 row_newbcast:0 row_mask:0xf bank_mask:0xf
  v_and_b32_dpp v50, v40, v4 row_newbcast:0 row_mask:0xf bank_mask:0xf
  v_and_b32_dpp v51, v40, v5 row_newbcast:0 row_mask:0xf bank_mask:0xf
  s_waitcnt vmcnt(31)
  s_nop 0
  v_mfma_f32_16x16x32_bf16 v[14:17], v[48:51], v[128:131], v[14:17]
  v_and_b32_dpp v52, v40, v2 row_newbcast:8 row_mask:0xf bank_mask:0xf
  v_and_b32_dpp v53, v40, v3 row_newbcast:8 row_mask:0xf bank_mask:0xf
  v_and_b32_dpp v54, v40, v4 row_newbcast:8 row_mask:0xf bank_mask:0xf
  v_and_b32_dpp v55, v40, v5 row_newbcast:8 row_mask:0xf bank_mask:0xf
  s_waitcnt vmcnt(30)
  s_nop 0
  v_mfma_f32_16x16x32_bf16 v[14:17], v[52:55], v[132:135], v[14:17]
  v_and_b32_dpp v48, v40, v2 row_newbcast:4 row_mask:0xf bank_mask:0xf
  v_and_b32_dpp v49, v40, v3 row_newbcast:4 row_mask:0xf bank_mask:0xf
  v_and_b32_dpp v50, v40, v4 row_newbcast:4 row_mask:0xf bank_mask:0xf
  v_and_b32_dpp v51, v40, v5 row_newbcast:4 row_mask:0xf bank_mask:0xf
  s_waitcnt vmcnt(29)
  s_nop 0
  v_mfma_f32_16x16x32_bf16 v[14:17], v[48:51], v[136:139], v[14:17]
  v_and_b32_dpp v52, v40, v2 row_newbcast:12 row_mask:0xf bank_mask:0xf
  v_and_b32_dpp v53, v40, v3 row_newbcast:12 row_mask:0xf bank_mask:0xf
  v_and_b32_dpp v54, v40, v4 row_newbcast:12 row_mask:0xf bank_mask:0xf
  v_and_b32_dpp v55, v40, v5 row_newbcast:12 row_mask:0xf bank_mask:0xf
  s_waitcnt vmcnt(28)
  s_nop 0
  v_mfma_f32_16x16x32_bf16 v[14:17], v[52:55], v[140:143], v[14:17]
  v_and_b32_dpp v48, v41, v2 row_newbcast:0 row_mask:0xf bank_mask:0xf
  v_and_b32_dpp v49, v41, v3 row_newbcast:0 row_mask:0xf bank_mask:0xf
  v_and_b32_dpp v50, v41, v4 row_newbcast:0 row_mask:0xf bank_mask:0xf
  v_and_b32_dpp v51, v41, v5 row_newbcast:0 row_mask:0xf bank_mask:0xf
  s_waitcnt vmcnt(27)
  s_nop 0
  v_mfma_f32_16x16x32_bf16 v[14:17], v[48:51], v[144:147], v[14:17]
  v_and_b32_dpp v52, v41, v2 row_newbcast:8 row_mask:0xf bank_mask:0xf
  v_and_b32_dpp v53, v41, v3 row_newbcast:8 row_mask:0xf bank_mask:0xf
  v_and_b32_dpp v54, v41, v4 row_newbcast:8 row_mask:0xf bank_mask:0xf
  v_and_b32_dpp v55, v41, v5 row_newbcast:8 row_mask:0xf bank_mask:0xf
  s_waitcnt vmcnt(26)
  s_nop 0
  v_mfma_f32_16x16x32_bf16 v[14:17], v[52:55], v[148:151], v[14:17]
  v_and_b32_dpp v48, v41, v2 row_newbcast:4 row_mask:0xf bank_mask:0xf
  v_and_b32_dpp v49, v41, v3 row_newbcast:4 row_mask:0xf bank_mask:0xf
  v_and_b32_dpp v50, v41, v4 row_newbcast:4 row_mask:0xf bank_mask:0xf
  v_and_b32_dpp v51, v41, v5 row_newbcast:4 row_mask:0xf bank_mask:0xf
  s_waitcnt vmcnt(25)
  s_nop 0
  v_mfma_f32_16x16x32_bf16 v[14:17], v[48:51], v[152:155], v[14:17]
  v_and_b32_dpp v52, v41, v2 row_newbcast:12 row_mask:0xf bank_mask:0xf
  v_and_b32_dpp v53, v41, v3 row_newbcast:12 row_mask:0xf bank_mask:0xf
  v_and_b32_dpp v54, v41, v4 row_newbcast:12 row_mask:0xf bank_mask:0xf
  v_and_b32_dpp v55, v41, v5 row_newbcast:12 row_mask:0xf bank_mask:0xf
  s_waitcnt vmcnt(24)
  s_nop 0
  v_mfma_f32_16x16x32_bf16 v[14:17], v[52:55], v[156:159], v[14:17]
  v_and_b32_dpp v48, v42, v2 row_newbcast:0 row_mask:0xf bank_mask:0xf
  v_and_b32_dpp v49, v42, v3 row_newbcast:0 row_mask:0xf bank_mask:0xf
  v_and_b32_dpp v50, v42, v4 row_newbcast:0 row_mask:0xf bank_mask:0xf
  v_and_b32_dpp v51, v42, v5 row_newbcast:0 row_mask:0xf bank_mask:0xf
  s_waitcnt vmcnt(23)
  s_nop 0
  v_mfma_f32_16x16x32_bf16 v[14:17], v[48:51], v[160:163], v[14:17]
  v_and_b32_dpp v52, v42, v2 row_newbcast:8 row_mask:0xf bank_mask:0xf
  v_and_b32_dpp v53, v42, v3 row_newbcast:8 row_mask:0xf bank_mask:0xf
  v_and_b32_dpp v54, v42, v4 row_newbcast:8 row_mask:0xf bank_mask:0xf
  v_and_b32_dpp v55, v42, v5 row_newbcast:8 row_mask:0xf bank_mask:0xf
  s_waitcnt vmcnt(22)
  s_nop 0
  v_mfma_f32_16x16x32_bf16 v[14:17], v[52:55], v[164:167], v[14:17]
  v_and_b32_dpp v48, v42, v2 row_newbcast:4 row_mask:0xf bank_mask:0xf
  v_and_b32_dpp v49, v42, v3 row_newbcast:4 row_mask:0xf bank_mask:0xf
  v_and_b32_dpp v50, v42, v4 row_newbcast:4 row_mask:0xf bank_mask:0xf
  v_and_b32_dpp v51, v42, v5 row_newbcast:4 row_mask:0xf bank_mask:0xf
  s_waitcnt vmcnt(21)
  s_nop 0
  v_mfma_f32_16x16x32_bf16 v[14:17], v[48:51], v[168:171], v[14:17]
  v_and_b32_dpp v52, v42, v2 row_newbcast:12 row_mask:0xf bank_mask:0xf
  v_and_b32_dpp v53, v42, v3 row_newbcast:12 row_mask:0xf bank_mask:0xf
  v_and_b32_dpp v54, v42, v4 row_newbcast:12 row_mask:0xf bank_mask:0xf
  v_and_b32_dpp v55, v42, v5 row_newbcast:12 row_mask:0xf bank_mask:0xf
  s_waitcnt vmcnt(20)
  s_nop 0
  v_mfma_f32_16x16x32_bf16 v[14:17], v[52:55], v[172:175], v[14:17]
  v_and_b32_dpp v48, v43, v2 row_newbcast:0 row_mask:0xf bank_mask:0xf
  v_and_b32_dpp v49, v43, v3 row_newbcast:0 row_mask:0xf bank_mask:0xf
  v_and_b32_dpp v50, v43, v4 row_newbcast:0 row_mask:0xf bank_mask:0xf
  v_and_b32_dpp v51, v43, v5 row_newbcast:0 row_mask:0xf bank_mask:0xf
  s_waitcnt vmcnt(19)
  s_nop 0
  v_mfma_f32_16x16x32_bf16 v[14:17], v[48:51], v[176:179], v[14:17]
  v_and_b32_dpp v52, v43, v2 row_newbcast:8 row_mask:0xf bank_mask:0xf
  v_and_b32_dpp v53, v43, v3 row_newbcast:8 row_mask:0xf bank_mask:0xf
  v_and_b32_dpp v54, v43, v4 row_newbcast:8 row_mask:0xf bank_mask:0xf
  v_and_b32_dpp v55, v43, v5 row_newbcast:8 row_mask:0xf bank_mask:0xf
  s_waitcnt vmcnt(18)
  s_nop 0
  v_mfma_f32_16x16x32_bf16 v[14:17], v[52:55], v[180:183], v[14:17]
  v_and_b32_dpp v48, v43, v2 row_newbcast:4 row_mask:0xf bank_mask:0xf
  v_and_b32_dpp v49, v43, v3 row_newbcast:4 row_mask:0xf bank_mask:0xf
  v_and_b32_dpp v50, v43, v4 row_newbcast:4 row_mask:0xf bank_mask:0xf
  v_and_b32_dpp v51, v43, v5 row_newbcast:4 row_mask:0xf bank_mask:0xf
  s_waitcnt vmcnt(17)
  s_nop 0
  v_mfma_f32_16x16x32_bf16 v[14:17], v[48:51], v[184:187], v[14:17]
  v_and_b32_dpp v52, v43, v2 row_newbcast:12 row_mask:0xf bank_mask:0xf
  v_and_b32_dpp v53, v43, v3 row_newbcast:12 row_mask:0xf bank_mask:0xf
  v_and_b32_dpp v54, v43, v4 row_newbcast:12 row_mask:0xf bank_mask:0xf
  v_and_b32_dpp v55, v43, v5 row_newbcast:12 row_mask:0xf bank_mask:0xf
  s_waitcnt vmcnt(16)
  s_nop 0
  v_mfma_f32_16x16x32_bf16 v[14:17], v[52:55], v[188:191], v[14:17]
L_tail:
  s_cmp_eq_u32 s10, 0
  s_cbranch_scc1 L_done
  s_mov_b32 s46, s42
  v_mov_b32 v22, 1
  buffer_atomic_add v22, v20, s[20:23], 0 offen offset:128 sc0 sc1
L_noat:
  buffer_load_dwordx4 v[128:131], v6, s[12:15], s24 offen offset:0 nt
  buffer_load_dwordx4 v[132:135], v6, s[12:15], s24 offen offset:256 nt
  buffer_load_dwordx4 v[136:139], v6, s[12:15], s66 offen offset:0 nt
  buffer_load_dwordx4 v[140:143], v6, s[12:15], s66 offen offset:256 nt
  buffer_load_dwordx4 v[144:147], v7, s[12:15], s24 offen offset:0 nt
  buffer_load_dwordx4 v[148:151], v7, s[12:15], s24 offen offset:256 nt
  buffer_load_dwordx4 v[152:155], v7, s[12:15], s66 offen offset:0 nt
  buffer_load_dwordx4 v[156:159], v7, s[12:15], s66 offen offset:256 nt
  buffer_load_dwordx4 v[160:163], v8, s[44:47], s24 offen offset:0 nt
  buffer_load_dwordx4 v[164:167], v8, s[44:47], s24 offen offset:256 nt
  buffer_load_dwordx4 v[168:171], v8, s[44:47], s66 offen offset:0 nt
  buffer_load_dwordx4 v[172:175], v8, s[44:47], s66 offen offset:256 nt
  buffer_load_dwordx4 v[176:179], v9, s[44:47], s24 offen offset:0 nt
  buffer_load_dwordx4 v[180:183], v9, s[44:47], s24 offen offset:256 nt
  buffer_load_dwordx4 v[184:187], v9, s[44:47], s66 offen offset:0 nt
  buffer_load_dwordx4 v[188:191], v9, s[44:47], s66 offen offset:256 nt
  s_branch L_loop
L_done:
  v_add_f32_dpp v19, v19, v19 row_ror:4 row_mask:0xf bank_mask:0xf
  s_nop 1
  v_add_f32_dpp v19, v19, v19 row_ror:8 row_mask:0xf bank_mask:0xf
  v_mov_b32 v23, v19
  s_nop 1
  v_permlane16_swap_b32 v19, v23
  v_add_f32 v19, v19, v23
  v_mov_b32 v23, v19
  s_nop 1
  v_permlane32_swap_b32 v19, v23
  v_add_f32 v19, v19, v23
  v_permlane32_swap_b32 v14, v16
  v_permlane32_swap_b32 v15, v17
  v_mov_b32 v16, v18
  v_mov_b32 v17, v19
  v_and_or_b32 v14, v14, -16, s30
  v_and_or_b32 v15, v15, -16, s31
  v_and_or_b32 v16, v16, -16, s32
  v_and_or_b32 v17, v17, -16, s33
  buffer_store_dwordx4 v[14:17], v56, s[20:23], s65 offen sc0 sc1
  s_barrier
  s_cmp_lt_i32 s27, 0
  s_cbranch_scc1 L_send
  v_lshlrev_b32 v6, 4, v0
  v_add_u32 v7, 0x1000, v6
  s_mul_i32 s34, s27, 36864
  s_add_u32 s34, s34, 2097152
  s_lshl_b32 s7, s3, 10
  s_add_u32 s35, s34, s7
  s_add_u32 s35, s35, 0x8000
  s_lshl_b32 s7, s3, 13
  s_add_u32 s34, s34, s7
  s_mov_b32 s16, s36
  s_mov_b32 s17, s37
  s_mov_b32 s18, 2560
  s_mov_b32 s19, 0x20000
  s_lshl_b32 s24, s27, 6
  v_and_b32 v24, 3, v0
  v_lshlrev_b32 v24, 4, v24
  v_bfe_u32 v25, v0, 2, 1
  v_lshl_add_u32 v24, v25, 3, v24
  v_lshrrev_b32 v25, 4, v0
  v_lshl_add_u32 v24, v25, 1, v24
  buffer_load_ushort v26, v24, s[16:19], s24 offen
  v_lshlrev_b32 v27, 2, v0
  s_lshl_b32 s7, s3, 8
  s_add_u32 s7, s7, 6144
  v_add_u32 v28, s7, v27
  s_mov_b32 s6, 0
  s_cmp_eq_u32 s3, 3
  s_cselect_b32 s74, 0xffffff, -1
  s_cselect_b32 s75, 0, -1
L_zpoll:
  v_mov_b32 v196, s30
  v_mov_b32 v197, s31
  v_mov_b32 v198, s32
  v_mov_b32 v199, s33
  s_mov_b64 exec, s[74:75]
  buffer_load_dwordx4 v[196:199], v6, s[20:23], s35 offen sc0 sc1
  s_mov_b64 exec, -1
  s_waitcnt vmcnt(0)
  v_xor_b32 v196, s30, v196
  v_xor_b32 v197, s31, v197
  v_xor_b32 v198, s32, v198
  v_xor_b32 v199, s33, v199
  v_or3_b32 v29, v196, v197, v198
  v_or_b32 v29, v29, v199
  v_and_b32 v29, 15, v29
  v_cmp_ne_u32 vcc, 0, v29
  s_add_u32 s6, s6, 1
  s_cbranch_vccz L_zok
  s_cmp_lt_u32 s6, 0x4000
  s_cbranch_scc1 L_zpoll
L_zok:
  v_add_f32_dpp v196, v196, v196 row_ror:8 row_mask:0xf bank_mask:0xf
  v_add_f32_dpp v197, v197, v197 row_ror:8 row_mask:0xf bank_mask:0xf
  v_add_f32_dpp v198, v198, v198 row_ror:8 row_mask:0xf bank_mask:0xf
  v_add_f32_dpp v199, v199, v199 row_ror:8 row_mask:0xf bank_mask:0xf
  s_barrier
  buffer_load_dwordx4 v[132:135], v6, s[20:23], s34 offen offset:0 sc0 sc1
  buffer_load_dwordx4 v[136:139], v6, s[20:23], s34 offen offset:1024 sc0 sc1
  buffer_load_dwordx4 v[140:143], v6, s[20:23], s34 offen offset:2048 sc0 sc1
  buffer_load_dwordx4 v[144:147], v6, s[20:23], s34 offen offset:3072 sc0 sc1
  buffer_load_dwordx4 v[148:151], v7, s[20:23], s34 offen offset:0 sc0 sc1
  buffer_load_dwordx4 v[152:155], v7, s[20:23], s34 offen offset:1024 sc0 sc1
  buffer_load_dwordx4 v[156:159], v7, s[20:23], s34 offen offset:2048 sc0 sc1
  buffer_load_dwordx4 v[160:163], v7, s[20:23], s34 offen offset:3072 sc0 sc1
  s_sleep 6
  buffer_load_dwordx4 v[164:167], v6, s[20:23], s34 offen offset:0 sc0 sc1
  buffer_load_dwordx4 v[168:171], v6, s[20:23], s34 offen offset:1024 sc0 sc1
  buffer_load_dwordx4 v[172:175], v6, s[20:23], s34 offen offset:2048 sc0 sc1
  buffer_load_dwordx4 v[176:179], v6, s[20:23], s34 offen offset:3072 sc0 sc1
  buffer_load_dwordx4 v[180:183], v7, s[20:23], s34 offen offset:0 sc0 sc1
  buffer_load_dwordx4 v[184:187], v7, s[20:23], s34 offen offset:1024 sc0 sc1
  buffer_load_dwordx4 v[188:191], v7, s[20:23], s34 offen offset:2048 sc0 sc1
  buffer_load_dwordx4 v[192:195], v7, s[20:23], s34 offen offset:3072 sc0 sc1
L_fpoll:
  s_waitcnt vmcnt(14)
  v_bitop3_b32 v96, v132, v136, s30 bitop3:0x7e
  v_bitop3_b32 v97, v133, v137, s31 bitop3:0x7e
  v_bitop3_b32 v98, v134, v138, s32 bitop3:0x7e
  v_bitop3_b32 v99, v135, v139, s33 bitop3:0x7e
  v_pk_add_f32 v[64:65], v[132:133], v[136:137]
  v_pk_add_f32 v[66:67], v[134:135], v[138:139]
  v_or3_b32 v29, v96, v97, v98
  v_or_b32 v29, v29, v99
  s_waitcnt vmcnt(12)
  v_bitop3_b32 v100, v140, v144, s30 bitop3:0x7e
  v_bitop3_b32 v101, v141, v145, s31 bitop3:0x7e
  v_bitop3_b32 v102, v142, v146, s32 bitop3:0x7e
  v_bitop3_b32 v103, v143, v147, s33 bitop3:0x7e
  v_pk_add_f32 v[68:69], v[140:141], v[144:145]
  v_pk_add_f32 v[70:71], v[142:143], v[146:147]
  v_or3_b32 v29, v29, v100, v101
  v_or3_b32 v29, v29, v102, v103
  v_pk_add_f32 v[64:65], v[64:65], v[68:69]
  v_pk_add_f32 v[66:67], v[66:67], v[70:71]
  s_waitcnt vmcnt(10)
  v_bitop3_b32 v104, v148, v152, s30 bitop3:0x7e
  v_bitop3_b32 v105, v149, v153, s31 bitop3:0x7e
  v_bitop3_b32 v106, v150, v154, s32 bitop3:0x7e
  v_bitop3_b32 v107, v151, v155, s33 bitop3:0x7e
  v_pk_add_f32 v[72:73], v[148:149], v[152:153]
  v_pk_add_f32 v[74:75], v[150:151], v[154:155]
  v_or3_b32 v29, v29, v104, v105
  v_or3_b32 v29, v29, v106, v107
  v_pk_add_f32 v[64:65], v[64:65], v[72:73]
  v_pk_add_f32 v[66:67], v[66:67], v[74:75]
  s_waitcnt vmcnt(8)
  v_bitop3_b32 v108, v156, v160, s30 bitop3:0x7e
  v_bitop3_b32 v109, v157, v161, s31 bitop3:0x7e
  v_bitop3_b32 v110, v158, v162, s32 bitop3:0x7e
  v_bitop3_b32 v111, v159, v163, s33 bitop3:0x7e
  v_pk_add_f32 v[76:77], v[156:157], v[160:161]
  v_pk_add_f32 v[78:79], v[158:159], v[162:163]
  v_or3_b32 v29, v29, v108, v109
  v_or3_b32 v29, v29, v110, v111
  v_pk_add_f32 v[64:65], v[64:65], v[76:77]
  v_pk_add_f32 v[66:67], v[66:67], v[78:79]
  v_and_b32 v29, 15, v29
  v_cmp_ne_u32 vcc, 0, v29
  s_cbranch_vccz L_fok
  s_wqm_b64 exec, vcc
  buffer_load_dwordx4 v[132:135], v6, s[20:23], s34 offen offset:0 sc0 sc1
  buffer_load_dwordx4 v[136:139], v6, s[20:23], s34 offen offset:1024 sc0 sc1
  buffer_load_dwordx4 v[140:143], v6, s[20:23], s34 offen offset:2048 sc0 sc1
  buffer_load_dwordx4 v[144:147], v6, s[20:23], s34 offen offset:3072 sc0 sc1
  buffer_load_dwordx4 v[148:151], v7, s[20:23], s34 offen offset:0 sc0 sc1
  buffer_load_dwordx4 v[152:155], v7, s[20:23], s34 offen offset:1024 sc0 sc1
  buffer_load_dwordx4 v[156:159], v7, s[20:23], s34 offen offset:2048 sc0 sc1
  buffer_load_dwordx4 v[160:163], v7, s[20:23], s34 offen offset:3072 sc0 sc1
  s_waitcnt vmcnt(14)
  v_bitop3_b32 v96, v164, v168, s30 bitop3:0x7e
  v_bitop3_b32 v97, v165, v169, s31 bitop3:0x7e
  v_bitop3_b32 v98, v166, v170, s32 bitop3:0x7e
  v_bitop3_b32 v99, v167, v171, s33 bitop3:0x7e
  v_pk_add_f32 v[64:65], v[164:165], v[168:169]
  v_pk_add_f32 v[66:67], v[166:167], v[170:171]
  v_or3_b32 v29, v96, v97, v98
  v_or_b32 v29, v29, v99
  s_waitcnt vmcnt(12)
  v_bitop3_b32 v100, v172, v176, s30 bitop3:0x7e
  v_bitop3_b32 v101, v173, v177, s31 bitop3:0x7e
  v_bitop3_b32 v102, v174, v178, s32 bitop3:0x7e
  v_bitop3_b32 v103, v175, v179, s33 bitop3:0x7e
  v_pk_add_f32 v[68:69], v[172:173], v[176:177]
  v_pk_add_f32 v[70:71], v[174:175], v[178:179]
  v_or3_b32 v29, v29, v100, v101
  v_or3_b32 v29, v29, v102, v103
  v_pk_add_f32 v[64:65], v[64:65], v[68:69]
  v_pk_add_f32 v[66:67], v[66:67], v[70:71]
  s_waitcnt vmcnt(10)
  v_bitop3_b32 v104, v180, v184, s30 bitop3:0x7e
  v_bitop3_b32 v105, v181, v185, s31 bitop3:0x7e
  v_bitop3_b32 v106, v182, v186, s32 bitop3:0x7e
  v_bitop3_b32 v107, v183, v187, s33 bitop3:0x7e
  v_pk_add_f32 v[72:73], v[180:181], v[184:185]
  v_pk_add_f32 v[74:75], v[182:183], v[186:187]
  v_or3_b32 v29, v29, v104, v105
  v_or3_b32 v29, v29, v106, v107
  v_pk_add_f32 v[64:65], v[64:65], v[72:73]
  v_pk_add_f32 v[66:67], v[66:67], v[74:75]
  s_waitcnt vmcnt(8)
  v_bitop3_b32 v108, v188, v192, s30 bitop3:0x7e
  v_bitop3_b32 v109, v189, v193, s31 bitop3:0x7e
  v_bitop3_b32 v110, v190, v194, s32 bitop3:0x7e
  v_bitop3_b32 v111, v191, v195, s33 bitop3:0x7e
  v_pk_add_f32 v[76:77], v[188:189], v[192:193]
  v_pk_add_f32 v[78:79], v[190:191], v[194:195]
  v_or3_b32 v29, v29, v108, v109
  v_or3_b32 v29, v29, v110, v111
  v_pk_add_f32 v[64:65], v[64:65], v[76:77]
  v_pk_add_f32 v[66:67], v[66:67], v[78:79]
  v_and_b32 v29, 15, v29
  v_cmp_ne_u32 vcc, 0, v29
  s_cbranch_vccz L_fok
  s_wqm_b64 exec, vcc
  buffer_load_dwordx4 v[164:167], v6, s[20:23], s34 offen offset:0 sc0 sc1
  buffer_load_dwordx4 v[168:171], v6, s[20:23], s34 offen offset:1024 sc0 sc1
  buffer_load_dwordx4 v[172:175], v6, s[20:23], s34 offen offset:2048 sc0 sc1
  buffer_load_dwordx4 v[176:179], v6, s[20:23], s34 offen offset:3072 sc0 sc1
  buffer_load_dwordx4 v[180:183], v7, s[20:23], s34 offen offset:0 sc0 sc1
  buffer_load_dwordx4 v[184:187], v7, s[20:23], s34 offen offset:1024 sc0 sc1
  buffer_load_dwordx4 v[188:191], v7, s[20:23], s34 offen offset:2048 sc0 sc1
  buffer_load_dwordx4 v[192:195], v7, s[20:23], s34 offen offset:3072 sc0 sc1
  s_add_u32 s6, s6, 1
  s_cmp_lt_u32 s6, 0x4000
  s_cbranch_scc1 L_fpoll
L_fok:
  s_mov_b64 exec, -1
  v_add_f32_dpp v196, v64, v64 row_ror:8 row_mask:0xf bank_mask:0x3
  v_add_f32_dpp v197, v65, v65 row_ror:8 row_mask:0xf bank_mask:0x3
  v_add_f32_dpp v198, v66, v66 row_ror:8 row_mask:0xf bank_mask:0x3
  v_add_f32_dpp v199, v67, v67 row_ror:8 row_mask:0xf bank_mask:0x3
  v_permlane16_swap_b32 v196, v197
  s_nop 0
  v_permlane16_swap_b32 v198, v199
  v_add_f32 v196, v196, v197
  v_add_f32 v198, v198, v199
  s_nop 1
  v_permlane32_swap_b32 v196, v198
  v_add_f32 v196, v196, v198
  ds_write_b32 v28, v196
  s_waitcnt lgkmcnt(0)
  s_barrier
  s_cmp_lg_u32 s3, 0
  s_cbranch_scc1 L_send
  ds_read2st64_b32 v[30:31], v27 offset0:24 offset1:25
  ds_read2st64_b32 v[32:33], v27 offset0:26 offset1:27
  s_mov_b32 s16, s54
  s_mov_b32 s17, s55
  v_lshlrev_b32 v26, 16, v26
  s_waitcnt lgkmcnt(0)
  v_add_f32 v30, v30, v31
  v_add_f32 v32, v32, v33
  v_add_f32 v30, v30, v32
  v_cvt_pk_bf16_f32 v30, v30, v30
  v_and_b32 v30, s26, v30
  s_nop 1
  v_mov_b32_dpp v31, v30 row_ror:8 row_mask:0xf bank_mask:0xf
  v_mul_f32 v32, 0xbfb8aa3b, v31
  v_exp_f32 v32, v32
  s_nop 0
  v_add_f32 v32, 1.0, v32
  v_rcp_f32 v32, v32
  s_nop 0
  v_mul_f32 v31, v31, v32
  v_cvt_pk_bf16_f32 v31, v31, v31
  v_and_b32 v31, s26, v31
  v_mul_f32 v30, v30, v31
  v_cvt_pk_bf16_f32 v30, v30, v30
  v_and_b32 v30, s26, v30
  v_add_f32 v30, v30, v26
  v_cvt_pk_bf16_f32 v30, v30, v30
  s_mov_b32 exec_lo, 0x00ff00ff
  s_mov_b32 exec_hi, 0x00ff00ff
  buffer_store_short v30, v24, s[16:19], s24 offen sc0 sc1
  s_cmp_lg_u32 s27, 0
  s_cbranch_scc1 L_send
  s_lshl_b32 s32, s32, 4
  s_lshl_b32 s33, s33, 8
  s_or_b32 s30, s30, s32
  s_or_b32 s30, s30, s33
  s_mov_b64 exec, 1
  v_mov_b32 v31, s30
  v_mov_b32 v32, 0
  buffer_store_dword v31, v32, s[20:23], 0 offen sc0 sc1
L_send:
  s_endpgm
L_exit:
  s_endpgm
.section .rodata,"a"
.p2align 6
.amdhsa_kernel recurrent_scan__mha_block_cached__glu_gated_geglu__decode_kernel
  .amdhsa_next_free_vgpr 256
  .amdhsa_next_free_sgpr 96
  .amdhsa_accum_offset 256
  .amdhsa_group_segment_fixed_size 0
  .amdhsa_kernarg_size 96
  .amdhsa_user_sgpr_count 2
  .amdhsa_user_sgpr_kernarg_segment_ptr 1
  .amdhsa_system_sgpr_workgroup_id_x 1
.end_amdhsa_kernel
```
